```python
import torch

def _softmax(x, axis=-1):
    return torch.softmax(x, dim=axis)
def _gelu(x):
    return torch.nn.functional.gelu(x, approximate="tanh")
def _silu(x):
    return torch.nn.functional.silu(x)
def _sigmoid(x):
    return torch.sigmoid(x)
def _layernorm(x, axis=-1, eps=1e-5):
    m = x.mean(dim=axis, keepdim=True)
    v = x.var(dim=axis, keepdim=True, unbiased=False)
    return (x - m) / torch.sqrt(v + eps)
def _scatter_add(tgt, idx, src, axis=0):
    return tgt.clone().index_add_(axis, idx, src)
def _segment_sum(src, seg, n):
    out = torch.zeros((n,) + src.shape[1:], dtype=src.dtype)
    return out.index_add_(0, seg, src)
def _pad(x, pw):
    flat = tuple(v for pair in reversed(pw) for v in pair)
    return torch.nn.functional.pad(x, flat)

kernel_name = 'concat_heads__ssm_conv_s4__linear_attn_block__prompt'

def setup_inputs():

    _w = (lambda a: (lambda t: t.to(torch.bfloat16) if t.is_floating_point() else t)(torch.as_tensor(a)))
    def _A_setup():
        B, L, D, N = 1, 2048, 512, 128
        A_re = -(lambda _x: torch.exp(torch.as_tensor(_x)))((lambda *s: torch.randn(*s, dtype=torch.bfloat16) * 6.4)(D, N))
        A_im = torch.pi * (lambda *s: torch.randn(*s, dtype=torch.bfloat16) * 0.05)(D, N)
        B_re = (lambda *s: torch.randn(*s, dtype=torch.bfloat16) * 0.1)(D, N)
        B_im = (lambda *s: torch.randn(*s, dtype=torch.bfloat16) * 0.1)(D, N)
        C_re = (lambda *s: torch.randn(*s, dtype=torch.bfloat16) * 0.1)(D, N)
        C_im = (lambda *s: torch.randn(*s, dtype=torch.bfloat16) * 0.1)(D, N)
        log_dt = (lambda *s: torch.randn(*s, dtype=torch.bfloat16) * 0.05)(D) * 0.5 - 4.0
        Dskip = (lambda *s: torch.randn(*s, dtype=torch.bfloat16) * 0.05)(D)
        return {
            "u": _w((lambda *s: torch.randn(*s, dtype=torch.bfloat16) * 0.05)(B, L, D)),
            "A_re": _w(A_re),
            "A_im": _w(A_im),
            "B_re": _w(B_re),
            "B_im": _w(B_im),
            "C_re": _w(C_re),
            "C_im": _w(C_im),
            "log_dt": _w(log_dt),
            "Dskip": _w(Dskip),
        }
    _A_in = _A_setup()

    def _B_setup():
        B, S, D = 1, 2048, 512
        return {
            "x": _w((lambda *s: torch.randn(*s, dtype=torch.bfloat16) * 0.05)(B, S, D)),
            "wqkv": _w((lambda *s: torch.randn(*s, dtype=torch.bfloat16) * 0.4)(D, 3 * D)),
            "wo": _w((lambda *s: torch.randn(*s, dtype=torch.bfloat16) * 0.05)(D, D)),
        }
    _B_in = _B_setup()

    return {
        "A_u": _A_in["u"],
        "A_A_re": _A_in["A_re"],
        "A_A_im": _A_in["A_im"],
        "A_B_re": _A_in["B_re"],
        "A_B_im": _A_in["B_im"],
        "A_C_re": _A_in["C_re"],
        "A_C_im": _A_in["C_im"],
        "A_log_dt": _A_in["log_dt"],
        "A_Dskip": _A_in["Dskip"],
        "B_x": _B_in["x"],
        "B_wqkv": _B_in["wqkv"],
        "B_wo": _B_in["wo"],
    }

def reference(A_u, A_A_re, A_A_im, A_B_re, A_B_im, A_C_re, A_C_im, A_log_dt, A_Dskip, B_x, B_wqkv, B_wo):
    def _A_ref(u, A_re, A_im, B_re, B_im, C_re, C_im, log_dt, Dskip):
        Bsz, L, D = u.shape
        dt = torch.exp(log_dt)[:, None]
        A = A_re + 1j * A_im
        Bc = B_re + 1j * B_im
        Cc = C_re + 1j * C_im
        logdA = dt * A
        dB = dt * Bc
        l = (lambda x, dt: x.to(dt))(torch.arange(L), A_re.dtype)
        P = torch.exp(logdA[:, :, None] * l[None, None, :])
        K = torch.einsum("dn,dnl,dn->dl", Cc, P, dB).real
        L2 = 2 * L
        Kp = _pad(K, ((0, 0), (0, L)))
        up = (lambda x, *d: x.permute(*d))(u, 0, 2, 1)
        up = _pad(up, ((0, 0), (0, 0), (0, L)))
        Kf = (lambda x, axes=(-2,-1): torch.fft.rfft2(x.float(), dim=axes))(Kp[:, None, :], axes=(-2, -1))
        Uf = (lambda x, axes=(-2,-1): torch.fft.rfft2(x.float(), dim=axes))(up[:, :, None, :], axes=(-2, -1))
        Yf = Uf * Kf[None, :, :, :]
        y = (lambda x, s, axes=(-2,-1): torch.fft.irfft2(x, s=s, dim=axes).to(torch.bfloat16))(Yf, (1, L2), axes=(-2, -1))[:, :, 0, :L]
        y = (lambda x, *d: x.permute(*d))(y, 0, 2, 1) + u * Dskip[None, None, :]
        return y

    def _B_ref(x, wqkv, wo):
        B, S, D = x.shape
        H = 32; Dh = D // H
        qkv = (lambda x, *d: x.permute(*d))((x @ wqkv).reshape(B, S, 3, H, Dh), 2, 0, 3, 1, 4)
        q, k, v = qkv[0], qkv[1], qkv[2]
        phi = lambda t: torch.where(t > 0, t + 1, torch.exp(t)) + 1e-6
        pq, pk = phi(q), phi(k)
        kv = torch.einsum("bhsd,bhse->bhde", pk, v)
        z = torch.einsum("bhsd->bhd", pk)
        num = torch.einsum("bhqd,bhde->bhqe", pq, kv)
        den = torch.einsum("bhqd,bhd->bhq", pq, z)[..., None] + 1e-6
        o = num / den
        return (lambda x, *d: x.permute(*d))(o, 0, 2, 1, 3).reshape(B, S, D) @ wo

    a = _A_ref(A_u, A_A_re, A_A_im, A_B_re, A_B_im, A_C_re, A_C_im, A_log_dt, A_Dskip)
    b = _B_ref(B_x, B_wqkv, B_wo)
    return torch.concatenate([a, b], axis=-1)
```

```asm
; @launch grid=(256,1,1) block=(512,1,1) lds=163840
.amdgcn_target "amdgcn-amd-amdhsa--gfx950"
.text
.globl concat_heads__ssm_conv_s4__linear_attn_block__prompt_kernel
.p2align 8
.type concat_heads__ssm_conv_s4__linear_attn_block__prompt_kernel,@function
concat_heads__ssm_conv_s4__linear_attn_block__prompt_kernel:
    s_cmp_ge_u32 s2, 256
    s_cbranch_scc1 LF_end
    s_lshr_b32 s6, s2, 4
    s_lshl_b32 s6, s6, 3
    s_and_b32 s7, s2, 7
    s_add_u32 s6, s6, s7
    s_bitcmp1_b32 s2, 3
    s_cbranch_scc1 LF_B
    s_and_b32 s3, s6, 7
    s_lshl_b32 s3, s3, 4
    s_lshr_b32 s4, s6, 3
    s_add_u32 s3, s3, s4
    s_load_dwordx16 s[16:31], s[0:1], 0
    s_load_dwordx2 s[32:33], s[0:1], 64
    s_load_dwordx2 s[34:35], s[0:1], 96
    v_and_b32 v1, 63, v0
    v_lshrrev_b32 v2, 6, v0
    s_nop 0
    v_readfirstlane_b32 s44, v2
    s_nop 0
    s_and_b32 s52, s44, 3
    s_lshr_b32 s53, s44, 2
    s_lshl_b32 s45, s3, 2
    s_add_u32 s45, s45, s52
    s_lshl_b32 s46, s45, 8
    s_lshl_b32 s47, s53, 7
    s_add_u32 s46, s46, s47
    v_lshlrev_b32 v7, 1, v1
    v_add_u32 v7, s46, v7
    s_lshl_b32 s47, s45, 1
    v_mov_b32 v8, s47
    s_lshl_b32 s46, s52, 6
    v_add_u32 v12, s46, v1
    s_lshl_b32 s46, s3, 3
    v_lshlrev_b32 v10, 13, v12
    v_add_u32 v10, s46, v10
    v_add_u32 v9, 0xfffffc00, v10
    v_add_u32 v11, 4096, v10
    s_lshl_b32 s47, s4, 7
    s_and_b32 s49, s52, 1
    s_lshl_b32 s49, s49, 6
    s_add_u32 s47, s47, s49
    v_add_u32 v20, s47, v1
    v_lshlrev_b32 v20, 10, v20
    v_add_u32 v20, s46, v20
    s_waitcnt lgkmcnt(0)
    s_cmp_lt_u32 s6, 8
    s_cbranch_scc0 Lzp_1
    s_cmp_eq_u32 s44, 3
    s_cbranch_scc0 Lzp_1
    s_load_dwordx4 s[88:91], s[0:1], 104
    v_mov_b32 v200, 0
    v_mov_b32 v201, 0
    v_mov_b32 v202, 0
    v_mov_b32 v203, 0
    s_waitcnt lgkmcnt(0)
    s_mov_b32 s92, s90
    s_and_b32 s93, s91, 0xffff
    s_mov_b32 s94, 0x10000000
    s_mov_b32 s95, 0x20000
    v_lshlrev_b32 v204, 4, v1
    s_lshl_b32 s64, s6, 12
    v_add_u32 v205, s64, v204
    buffer_store_dwordx4 v[200:203], v205, s[92:95], 0 offen offset:0 sc1
    buffer_store_dwordx4 v[200:203], v205, s[92:95], 0 offen offset:1024 sc1
    buffer_store_dwordx4 v[200:203], v205, s[92:95], 0 offen offset:2048 sc1
    buffer_store_dwordx4 v[200:203], v205, s[92:95], 0 offen offset:3072 sc1
    s_lshl_b32 s64, s6, 8
    s_add_u32 s64, s64, 32768
    v_and_b32 v206, 15, v1
    v_lshlrev_b32 v205, 4, v206
    v_add_u32 v205, s64, v205
    buffer_store_dwordx4 v[200:203], v205, s[92:95], 0 offen sc1
    s_lshl_b32 s64, s6, 7
    s_add_u32 s64, s64, 65536
    v_and_b32 v206, 7, v1
    v_lshlrev_b32 v206, 10, v206
    v_add_u32 v206, s64, v206
    s_lshl_b32 s65, s6, 8
    s_add_u32 s65, s65, 72704
    v_lshlrev_b32 v205, 7, v1
    v_add_u32 v205, s65, v205
    v_add_u32 v207, -8, v1
    v_cmp_gt_u32 s[66:67], 2, v207
    s_nop 1
    v_cndmask_b32 v206, v206, v205, s[66:67]
    buffer_store_dword v200, v206, s[92:95], 0 offen sc1
    s_lshl_b32 s64, s6, 7
    s_add_u32 s64, s64, 77824
    v_mov_b32 v206, s64
    buffer_store_dword v200, v206, s[92:95], 0 offen sc1
Lzp_1:
    global_load_ushort v26, v8, s[30:31]
    global_load_ushort v27, v8, s[32:33]
    global_load_ushort v14, v7, s[18:19]
    global_load_ushort v15, v7, s[20:21]
    global_load_ushort v16, v7, s[22:23]
    global_load_ushort v17, v7, s[24:25]
    global_load_ushort v18, v7, s[26:27]
    global_load_ushort v19, v7, s[28:29]
    s_mov_b32 s36, s16
    s_and_b32 s37, s17, 0xffff
    s_mov_b32 s38, 0x200000
    s_mov_b32 s39, 0x20000
    s_mov_b32 s40, s34
    s_and_b32 s41, s35, 0xffff
    s_mov_b32 s42, 0x400000
    s_mov_b32 s43, 0x20000
    s_mul_i32 s48, s52, 17664
    s_mul_i32 s46, s52, 17408
    s_add_u32 s46, s46, 70656
    s_cmp_eq_u32 s53, 1
    s_cselect_b32 s48, s46, s48
    v_lshlrev_b32 v49, 2, v1
    v_add_u32 v49, s48, v49
    v_and_b32 v3, 31, v1
    v_mul_u32_u24 v50, 272, v3
    v_lshrrev_b32 v4, 5, v1
    v_lshlrev_b32 v4, 4, v4
    v_add3_u32 v50, v50, v4, s48
    s_lshl_b32 s46, s52, 12
    s_add_u32 s46, s46, 140288
    v_lshlrev_b32 v224, 4, v1
    v_add_u32 v224, s46, v224
    s_mul_i32 s68, s52, 17664
    v_lshlrev_b32 v225, 4, v1
    v_sub_u32 v225, s68, v225
    v_add_u32 v225, 1008, v225
    v_bfe_u32 v4, v1, 3, 2
    v_add_u32 v5, 0, v4
    v_and_b32 v5, 3, v5
    v_lshlrev_b32 v5, 2, v5
    v_add_u32 v226, v225, v5
    v_add_u32 v5, 1, v4
    v_and_b32 v5, 3, v5
    v_lshlrev_b32 v5, 2, v5
    v_add_u32 v227, v225, v5
    v_add_u32 v5, 2, v4
    v_and_b32 v5, 3, v5
    v_lshlrev_b32 v5, 2, v5
    v_add_u32 v228, v225, v5
    v_add_u32 v5, 3, v4
    v_and_b32 v5, 3, v5
    v_lshlrev_b32 v5, 2, v5
    v_add_u32 v229, v225, v5
    v_bfe_u32 v5, v1, 3, 1
    v_cmp_eq_u32 s[54:55], 1, v5
    v_bfe_u32 v5, v1, 4, 1
    v_cmp_eq_u32 s[56:57], 1, v5
    v_and_b32 v4, 1, v1
    v_cmp_eq_u32 s[58:59], 1, v4
    v_lshrrev_b32 v3, 3, v12
    v_add_u32 v3, v3, v12
    v_lshlrev_b32 v230, 4, v3
    v_add_u32 v230, 70672, v230
    v_and_b32 v3, 31, v1
    v_add_u32 v4, 1, v3
    v_and_b32 v4, 3, v4
    v_mul_u32_u24 v5, 4420, v4
    v_cmp_eq_u32 vcc, 0, v4
    v_mov_b32 v6, 16
    s_nop 0
    v_cndmask_b32 v5, v5, v6, vcc
    v_lshlrev_b32 v3, 2, v3
    v_sub_u32 v5, v5, v3
    v_lshrrev_b32 v4, 5, v1
    v_lshlrev_b32 v4, 4, v4
    s_lshl_b32 s46, s53, 10
    s_add_u32 s46, s46, s68
    v_add3_u32 v231, v5, v4, s46
    v_add_u32 v231, 124, v231
    v_and_b32 v3, 1, v1
    v_mul_u32_u24 v3, 4736, v3
    s_mul_i32 s46, s52, 9472
    s_add_u32 s46, s46, 70672
    v_add_u32 v3, s46, v3
    v_add_u32 v233, -16, v3
    v_add_u32 v234, -48, v3
    v_add_u32 v235, -80, v3
    v_add_u32 v236, -112, v3
    v_bfe_u32 v5, v1, 1, 4
    v_mul_u32_u24 v5, 144, v5
    v_add3_u32 v232, v3, v5, v4
    s_mul_i32 s46, s53, 1152
    s_add_u32 s46, s46, -2160
    v_add_u32 v232, s46, v232
    v_mov_b32 v192, 0
    v_mov_b32 v208, 0
    v_mov_b32 v193, 0
    v_mov_b32 v209, 0
    v_mov_b32 v194, 0
    v_mov_b32 v210, 0
    v_mov_b32 v195, 0
    v_mov_b32 v211, 0
    v_mov_b32 v196, 0
    v_mov_b32 v212, 0
    v_mov_b32 v197, 0
    v_mov_b32 v213, 0
    v_mov_b32 v198, 0
    v_mov_b32 v214, 0
    v_mov_b32 v199, 0
    v_mov_b32 v215, 0
    v_mov_b32 v200, 0
    v_mov_b32 v216, 0
    v_mov_b32 v201, 0
    v_mov_b32 v217, 0
    v_mov_b32 v202, 0
    v_mov_b32 v218, 0
    v_mov_b32 v203, 0
    v_mov_b32 v219, 0
    v_mov_b32 v204, 0
    v_mov_b32 v220, 0
    v_mov_b32 v205, 0
    v_mov_b32 v221, 0
    v_mov_b32 v206, 0
    v_mov_b32 v222, 0
    v_mov_b32 v207, 0
    v_mov_b32 v223, 0
    v_mov_b32 v240, 0
    v_mov_b32 v241, 0
    v_mov_b32 v242, 0
    v_mov_b32 v243, 0
    s_lshl_b32 s46, s44, 12
    v_lshlrev_b32 v246, 4, v1
    v_add_u32 v246, s46, v246
    v_xor_b32 v247, 0x4000, v246
    v_add_u32 v246, 108544, v246
    v_add_u32 v247, 108544, v247
    v_bfe_u32 v3, v1, 1, 4
    v_mul_u32_u24 v3, 528, v3
    v_and_b32 v4, 1, v1
    v_lshlrev_b32 v4, 3, v4
    v_lshrrev_b32 v5, 5, v1
    v_lshlrev_b32 v5, 6, v5
    v_add3_u32 v248, v3, v4, v5
    s_lshl_b32 s46, s52, 1
    s_mul_i32 s47, s53, 8448
    s_add_u32 s46, s46, s47
    s_add_u32 s46, s46, 141312
    v_add_u32 v248, s46, v248
    v_mov_b32 v251, v0
    v_lshrrev_b32 v3, 4, v251
    v_lshlrev_b32 v3, 4, v3
    v_lshlrev_b32 v4, 5, v251
    v_add3_u32 v249, v3, v4, 0
    v_add_u32 v249, 141312, v249
    v_lshlrev_b32 v250, 13, v251
    s_lshl_b32 s46, s3, 3
    v_add_u32 v250, s46, v250
    s_load_dwordx4 s[88:91], s[0:1], 72
    s_cmp_lt_u32 s44, 4
    s_cbranch_scc0 Lbt_2
    s_and_b32 s46, s7, 3
    s_lshl_b32 s46, s46, 9
    s_lshl_b32 s47, s4, 5
    s_add_u32 s46, s46, s47
    v_and_b32 v22, 31, v1
    v_add_u32 v22, s46, v22
    v_lshlrev_b32 v22, 10, v22
    v_lshrrev_b32 v3, 5, v1
    s_and_b32 s47, s44, 1
    s_lshl_b32 s47, s47, 1
    v_add_u32 v3, s47, v3
    v_lshlrev_b32 v3, 8, v3
    v_add3_u32 v22, v22, v3, 0
    v_add_u32 v22, 128, v22
    s_lshr_b32 s46, s4, 2
    s_lshl_b32 s46, s46, 1
    s_add_u32 s46, s46, 1
    s_lshl_b32 s46, s46, 6
    v_add_u32 v4, s46, v1
    v_mul_u32_u24 v4, 3072, v4
    s_lshr_b32 s46, s7, 2
    s_lshl_b32 s46, s46, 2
    s_and_b32 s47, s4, 3
    s_add_u32 s46, s46, s47
    s_lshl_b32 s46, s46, 7
    s_and_b32 s47, s44, 1
    s_add_u32 s47, s47, 1
    s_lshl_b32 s47, s47, 10
    s_add_u32 s46, s46, s47
    v_add_u32 v4, s46, v4
    s_waitcnt lgkmcnt(0)
    s_mov_b32 s60, s88
    s_and_b32 s61, s89, 0xffff
    s_mov_b32 s62, 0x200000
    s_mov_b32 s63, 0x20000
    s_mov_b32 s64, s90
    s_and_b32 s65, s91, 0xffff
    s_mov_b32 s66, 0x180000
    s_mov_b32 s67, 0x20000
    s_cmp_lt_u32 s44, 2
    s_cbranch_scc0 Lbt_3
    buffer_load_dword v23, v22, s[60:63], 0 offen
    s_branch Lbt_2
Lbt_3:
    buffer_load_dword v23, v4, s[64:67], 0 offen
Lbt_2:
    v_and_b32 v252, 7, v1
    v_lshlrev_b32 v252, 2, v252
    v_add_u32 v252, 156672, v252
    ds_write_b32 v252, v240
    s_waitcnt lgkmcnt(0)
    s_barrier
    s_cmp_lt_u32 s44, 2
    s_cbranch_scc0 Lw_4
    s_waitcnt vmcnt(1)
    s_branch Lw_5
Lw_4:
    s_cmp_lt_u32 s44, 4
    s_cbranch_scc0 Lw_6
    s_waitcnt vmcnt(1)
    s_branch Lw_5
Lw_6:
    s_waitcnt vmcnt(0)
Lw_5:
    s_cmp_lt_u32 s44, 2
    s_cbranch_scc0 Lt_7
    buffer_load_dword v21, v20, s[36:39], 0 offen
Lt_7:
    s_load_dwordx4 s[88:91], s[0:1], 80
    s_cmp_ge_u32 s44, 2
    s_cbranch_scc0 Lb2_8
    s_cmp_lt_u32 s44, 6
    s_cbranch_scc0 Lb2_8
    s_lshl_b32 s46, s4, 7
    s_and_b32 s47, s44, 1
    s_lshl_b32 s47, s47, 6
    s_add_u32 s46, s46, s47
    v_add_u32 v3, s46, v1
    v_lshrrev_b32 v4, 2, v3
    v_and_b32 v3, 3, v3
    s_lshr_b32 s46, s7, 2
    s_lshl_b32 s46, s46, 2
    v_add_u32 v3, s46, v3
    v_lshlrev_b32 v3, 7, v3
    v_mul_u32_u24 v5, 3072, v4
    v_add_u32 v5, v5, v3
    v_lshlrev_b32 v6, 10, v4
    v_add_u32 v6, v6, v3
    s_waitcnt lgkmcnt(0)
    s_mov_b32 s60, s88
    s_and_b32 s61, s89, 0xffff
    s_mov_b32 s62, 0x180000
    s_mov_b32 s63, 0x20000
    s_mov_b32 s64, s90
    s_and_b32 s65, s91, 0xffff
    s_mov_b32 s66, 0x80000
    s_mov_b32 s67, 0x20000
    s_cmp_lt_u32 s44, 4
    s_cbranch_scc0 Lb3_9
    buffer_load_dword v23, v5, s[60:63], 0 offen
    s_branch Lb2_8
Lb3_9:
    buffer_load_dword v23, v6, s[64:67], 0 offen
Lb2_8:
    s_cmp_lt_u32 s6, 8
    s_cbranch_scc0 Lzq_10
    s_cmp_eq_u32 s44, 3
    s_cbranch_scc0 Lzq_10
    s_waitcnt vmcnt(0)
    s_load_dwordx2 s[88:89], s[0:1], 104
    s_waitcnt lgkmcnt(0)
    s_mov_b32 s60, s88
    s_and_b32 s61, s89, 0xffff
    s_mov_b32 s62, 0x100
    s_mov_b32 s63, 0x20000
    s_lshl_b32 s64, s6, 2
    v_mov_b32 v245, s64
    v_mov_b32 v244, 1
    s_mov_b64 s[66:67], exec
    s_mov_b64 exec, 1
    buffer_store_dword v244, v245, s[60:63], 0 offen sc1
    s_mov_b64 exec, s[66:67]
Lzq_10:
    v_lshlrev_b32 v26, 16, v26
    v_lshlrev_b32 v27, 16, v27
    v_mul_f32 v46, 0x3fb8aa3b, v26
    v_exp_f32 v46, v46
    v_lshlrev_b32 v14, 16, v14
    v_lshlrev_b32 v15, 16, v15
    v_lshlrev_b32 v16, 16, v16
    v_lshlrev_b32 v17, 16, v17
    v_lshlrev_b32 v18, 16, v18
    v_lshlrev_b32 v19, 16, v19
    v_cvt_pk_bf16_f32 v46, v46, v46
    v_and_b32 v46, 0xffff0000, v46
    v_mul_f32 v47, 0x3fb8aa3b, v46
    v_mul_f32 v48, 0x3e22f983, v46
    v_cmp_eq_u32 vcc, 0, v1
    s_nop 1
    v_cndmask_b32 v51, 0, v27, vcc
    v_mul_f32 v72, v14, v47
    v_mul_f32 v73, v15, v48
    v_exp_f32 v72, v72
    v_rndne_f32 v76, v73
    v_sub_f32 v73, v73, v76
    v_pk_mul_f32 v[74:75], v[18:19], v[16:17] op_sel_hi:[0,1]
    v_pk_fma_f32 v[74:75], v[18:19], v[16:17], v[74:75] op_sel:[1,1,0] op_sel_hi:[1,0,1] neg_lo:[0,1,0]
    v_cos_f32 v52, v73
    v_sin_f32 v53, v73
    v_mul_f32 v70, v74, v46
    v_mul_f32 v71, v75, v46
    v_mul_f32 v52, v52, v72
    v_mul_f32 v53, v53, v72
    v_cvt_pk_bf16_f32 v96, v70, -v71
    ds_write_b32 v49, v96 offset:0
    v_pk_mul_f32 v[54:55], v[52:53], v[52:53] op_sel_hi:[0,1]
    v_pk_mul_f32 v[74:75], v[70:71], v[52:53] op_sel_hi:[0,1]
    v_pk_fma_f32 v[54:55], v[52:53], v[52:53], v[54:55] op_sel:[1,1,0] op_sel_hi:[1,0,1] neg_lo:[0,1,0]
    v_pk_fma_f32 v[74:75], v[70:71], v[52:53], v[74:75] op_sel:[1,1,0] op_sel_hi:[1,0,1] neg_lo:[0,1,0]
    v_cvt_pk_bf16_f32 v97, v74, -v75
    ds_write_b32 v49, v97 offset:272
    v_pk_mul_f32 v[56:57], v[54:55], v[54:55] op_sel_hi:[0,1]
    v_pk_mul_f32 v[76:77], v[70:71], v[54:55] op_sel_hi:[0,1]
    v_pk_mul_f32 v[78:79], v[74:75], v[54:55] op_sel_hi:[0,1]
    v_pk_fma_f32 v[56:57], v[54:55], v[54:55], v[56:57] op_sel:[1,1,0] op_sel_hi:[1,0,1] neg_lo:[0,1,0]
    v_pk_fma_f32 v[76:77], v[70:71], v[54:55], v[76:77] op_sel:[1,1,0] op_sel_hi:[1,0,1] neg_lo:[0,1,0]
    v_pk_fma_f32 v[78:79], v[74:75], v[54:55], v[78:79] op_sel:[1,1,0] op_sel_hi:[1,0,1] neg_lo:[0,1,0]
    v_cvt_pk_bf16_f32 v98, v76, -v77
    ds_write_b32 v49, v98 offset:544
    v_cvt_pk_bf16_f32 v99, v78, -v79
    ds_write_b32 v49, v99 offset:816
    v_pk_mul_f32 v[58:59], v[56:57], v[56:57] op_sel_hi:[0,1]
    v_pk_mul_f32 v[80:81], v[70:71], v[56:57] op_sel_hi:[0,1]
    v_pk_mul_f32 v[82:83], v[74:75], v[56:57] op_sel_hi:[0,1]
    v_pk_mul_f32 v[84:85], v[76:77], v[56:57] op_sel_hi:[0,1]
    v_pk_mul_f32 v[86:87], v[78:79], v[56:57] op_sel_hi:[0,1]
    v_pk_fma_f32 v[58:59], v[56:57], v[56:57], v[58:59] op_sel:[1,1,0] op_sel_hi:[1,0,1] neg_lo:[0,1,0]
    v_pk_fma_f32 v[80:81], v[70:71], v[56:57], v[80:81] op_sel:[1,1,0] op_sel_hi:[1,0,1] neg_lo:[0,1,0]
    v_pk_fma_f32 v[82:83], v[74:75], v[56:57], v[82:83] op_sel:[1,1,0] op_sel_hi:[1,0,1] neg_lo:[0,1,0]
    v_pk_fma_f32 v[84:85], v[76:77], v[56:57], v[84:85] op_sel:[1,1,0] op_sel_hi:[1,0,1] neg_lo:[0,1,0]
    v_pk_fma_f32 v[86:87], v[78:79], v[56:57], v[86:87] op_sel:[1,1,0] op_sel_hi:[1,0,1] neg_lo:[0,1,0]
    v_cvt_pk_bf16_f32 v96, v80, -v81
    ds_write_b32 v49, v96 offset:2176
    v_cvt_pk_bf16_f32 v97, v82, -v83
    ds_write_b32 v49, v97 offset:2448
    v_cvt_pk_bf16_f32 v98, v84, -v85
    ds_write_b32 v49, v98 offset:2720
    v_cvt_pk_bf16_f32 v99, v86, -v87
    ds_write_b32 v49, v99 offset:2992
    v_pk_mul_f32 v[60:61], v[58:59], v[58:59] op_sel_hi:[0,1]
    v_pk_fma_f32 v[60:61], v[58:59], v[58:59], v[60:61] op_sel:[1,1,0] op_sel_hi:[1,0,1] neg_lo:[0,1,0]
    v_mov_b32 v96, 0x00003f80
    ds_write_b32 v49, v96 offset:8704
    v_cvt_pk_bf16_f32 v97, v58, v59
    ds_write_b32 v49, v97 offset:8976
    v_pk_mul_f32 v[62:63], v[60:61], v[60:61] op_sel_hi:[0,1]
    v_pk_mul_f32 v[78:79], v[58:59], v[60:61] op_sel_hi:[0,1]
    v_pk_fma_f32 v[62:63], v[60:61], v[60:61], v[62:63] op_sel:[1,1,0] op_sel_hi:[1,0,1] neg_lo:[0,1,0]
    v_pk_fma_f32 v[78:79], v[58:59], v[60:61], v[78:79] op_sel:[1,1,0] op_sel_hi:[1,0,1] neg_lo:[0,1,0]
    v_cvt_pk_bf16_f32 v98, v60, v61
    ds_write_b32 v49, v98 offset:9248
    v_cvt_pk_bf16_f32 v99, v78, v79
    ds_write_b32 v49, v99 offset:9520
    v_pk_mul_f32 v[64:65], v[62:63], v[62:63] op_sel_hi:[0,1]
    v_pk_mul_f32 v[74:75], v[58:59], v[62:63] op_sel_hi:[0,1]
    v_pk_mul_f32 v[76:77], v[60:61], v[62:63] op_sel_hi:[0,1]
    v_pk_mul_f32 v[86:87], v[78:79], v[62:63] op_sel_hi:[0,1]
    v_pk_fma_f32 v[64:65], v[62:63], v[62:63], v[64:65] op_sel:[1,1,0] op_sel_hi:[1,0,1] neg_lo:[0,1,0]
    v_pk_fma_f32 v[74:75], v[58:59], v[62:63], v[74:75] op_sel:[1,1,0] op_sel_hi:[1,0,1] neg_lo:[0,1,0]
    v_pk_fma_f32 v[76:77], v[60:61], v[62:63], v[76:77] op_sel:[1,1,0] op_sel_hi:[1,0,1] neg_lo:[0,1,0]
    v_pk_fma_f32 v[86:87], v[78:79], v[62:63], v[86:87] op_sel:[1,1,0] op_sel_hi:[1,0,1] neg_lo:[0,1,0]
    v_cvt_pk_bf16_f32 v96, v62, v63
    ds_write_b32 v49, v96 offset:9792
    v_cvt_pk_bf16_f32 v97, v74, v75
    ds_write_b32 v49, v97 offset:10064
    v_cvt_pk_bf16_f32 v98, v76, v77
    ds_write_b32 v49, v98 offset:10336
    v_cvt_pk_bf16_f32 v99, v86, v87
    ds_write_b32 v49, v99 offset:10608
    v_pk_mul_f32 v[88:89], v[62:63], v[62:63] op_sel_hi:[0,1]
    v_pk_mul_f32 v[90:91], v[74:75], v[62:63] op_sel_hi:[0,1]
    v_pk_mul_f32 v[92:93], v[76:77], v[62:63] op_sel_hi:[0,1]
    v_pk_mul_f32 v[94:95], v[86:87], v[62:63] op_sel_hi:[0,1]
    v_pk_mul_f32 v[66:67], v[64:65], v[64:65] op_sel_hi:[0,1]
    v_pk_fma_f32 v[88:89], v[62:63], v[62:63], v[88:89] op_sel:[1,1,0] op_sel_hi:[1,0,1] neg_lo:[0,1,0]
    v_pk_fma_f32 v[90:91], v[74:75], v[62:63], v[90:91] op_sel:[1,1,0] op_sel_hi:[1,0,1] neg_lo:[0,1,0]
    v_pk_fma_f32 v[92:93], v[76:77], v[62:63], v[92:93] op_sel:[1,1,0] op_sel_hi:[1,0,1] neg_lo:[0,1,0]
    v_pk_fma_f32 v[94:95], v[86:87], v[62:63], v[94:95] op_sel:[1,1,0] op_sel_hi:[1,0,1] neg_lo:[0,1,0]
    v_pk_fma_f32 v[66:67], v[64:65], v[64:65], v[66:67] op_sel:[1,1,0] op_sel_hi:[1,0,1] neg_lo:[0,1,0]
    v_cvt_pk_bf16_f32 v96, v88, v89
    ds_write_b32 v49, v96 offset:10880
    v_cvt_pk_bf16_f32 v97, v90, v91
    ds_write_b32 v49, v97 offset:11152
    v_cvt_pk_bf16_f32 v98, v92, v93
    ds_write_b32 v49, v98 offset:11424
    v_cvt_pk_bf16_f32 v99, v94, v95
    ds_write_b32 v49, v99 offset:11696
    v_pk_mul_f32 v[78:79], v[88:89], v[62:63] op_sel_hi:[0,1]
    v_pk_mul_f32 v[80:81], v[90:91], v[62:63] op_sel_hi:[0,1]
    v_pk_mul_f32 v[82:83], v[92:93], v[62:63] op_sel_hi:[0,1]
    v_pk_mul_f32 v[84:85], v[94:95], v[62:63] op_sel_hi:[0,1]
    v_pk_mul_f32 v[68:69], v[66:67], v[66:67] op_sel_hi:[0,1]
    v_pk_fma_f32 v[78:79], v[88:89], v[62:63], v[78:79] op_sel:[1,1,0] op_sel_hi:[1,0,1] neg_lo:[0,1,0]
    v_pk_fma_f32 v[80:81], v[90:91], v[62:63], v[80:81] op_sel:[1,1,0] op_sel_hi:[1,0,1] neg_lo:[0,1,0]
    v_pk_fma_f32 v[82:83], v[92:93], v[62:63], v[82:83] op_sel:[1,1,0] op_sel_hi:[1,0,1] neg_lo:[0,1,0]
    v_pk_fma_f32 v[84:85], v[94:95], v[62:63], v[84:85] op_sel:[1,1,0] op_sel_hi:[1,0,1] neg_lo:[0,1,0]
    v_pk_fma_f32 v[68:69], v[66:67], v[66:67], v[68:69] op_sel:[1,1,0] op_sel_hi:[1,0,1] neg_lo:[0,1,0]
    v_cvt_pk_bf16_f32 v96, v78, v79
    ds_write_b32 v49, v96 offset:11968
    v_cvt_pk_bf16_f32 v97, v80, v81
    ds_write_b32 v49, v97 offset:12240
    v_cvt_pk_bf16_f32 v98, v82, v83
    ds_write_b32 v49, v98 offset:12512
    v_cvt_pk_bf16_f32 v99, v84, v85
    ds_write_b32 v49, v99 offset:12784
    v_pk_mul_f32 v[88:89], v[78:79], v[62:63] op_sel_hi:[0,1]
    v_pk_mul_f32 v[90:91], v[80:81], v[62:63] op_sel_hi:[0,1]
    v_pk_mul_f32 v[92:93], v[82:83], v[62:63] op_sel_hi:[0,1]
    v_pk_mul_f32 v[94:95], v[84:85], v[62:63] op_sel_hi:[0,1]
    v_pk_fma_f32 v[88:89], v[78:79], v[62:63], v[88:89] op_sel:[1,1,0] op_sel_hi:[1,0,1] neg_lo:[0,1,0]
    v_pk_fma_f32 v[90:91], v[80:81], v[62:63], v[90:91] op_sel:[1,1,0] op_sel_hi:[1,0,1] neg_lo:[0,1,0]
    v_pk_fma_f32 v[92:93], v[82:83], v[62:63], v[92:93] op_sel:[1,1,0] op_sel_hi:[1,0,1] neg_lo:[0,1,0]
    v_pk_fma_f32 v[94:95], v[84:85], v[62:63], v[94:95] op_sel:[1,1,0] op_sel_hi:[1,0,1] neg_lo:[0,1,0]
    v_cvt_pk_bf16_f32 v96, v88, v89
    ds_write_b32 v49, v96 offset:13056
    v_cvt_pk_bf16_f32 v97, v90, v91
    ds_write_b32 v49, v97 offset:13328
    v_cvt_pk_bf16_f32 v98, v92, v93
    ds_write_b32 v49, v98 offset:13600
    v_cvt_pk_bf16_f32 v99, v94, v95
    ds_write_b32 v49, v99 offset:13872
    v_pk_mul_f32 v[78:79], v[88:89], v[62:63] op_sel_hi:[0,1]
    v_pk_mul_f32 v[80:81], v[90:91], v[62:63] op_sel_hi:[0,1]
    v_pk_mul_f32 v[82:83], v[92:93], v[62:63] op_sel_hi:[0,1]
    v_pk_mul_f32 v[84:85], v[94:95], v[62:63] op_sel_hi:[0,1]
    v_pk_fma_f32 v[78:79], v[88:89], v[62:63], v[78:79] op_sel:[1,1,0] op_sel_hi:[1,0,1] neg_lo:[0,1,0]
    v_pk_fma_f32 v[80:81], v[90:91], v[62:63], v[80:81] op_sel:[1,1,0] op_sel_hi:[1,0,1] neg_lo:[0,1,0]
    v_pk_fma_f32 v[82:83], v[92:93], v[62:63], v[82:83] op_sel:[1,1,0] op_sel_hi:[1,0,1] neg_lo:[0,1,0]
    v_pk_fma_f32 v[84:85], v[94:95], v[62:63], v[84:85] op_sel:[1,1,0] op_sel_hi:[1,0,1] neg_lo:[0,1,0]
    v_cvt_pk_bf16_f32 v96, v78, v79
    ds_write_b32 v49, v96 offset:14144
    v_cvt_pk_bf16_f32 v97, v80, v81
    ds_write_b32 v49, v97 offset:14416
    v_cvt_pk_bf16_f32 v98, v82, v83
    ds_write_b32 v49, v98 offset:14688
    v_cvt_pk_bf16_f32 v99, v84, v85
    ds_write_b32 v49, v99 offset:14960
    v_pk_mul_f32 v[88:89], v[78:79], v[62:63] op_sel_hi:[0,1]
    v_pk_mul_f32 v[90:91], v[80:81], v[62:63] op_sel_hi:[0,1]
    v_pk_mul_f32 v[92:93], v[82:83], v[62:63] op_sel_hi:[0,1]
    v_pk_mul_f32 v[94:95], v[84:85], v[62:63] op_sel_hi:[0,1]
    v_pk_fma_f32 v[88:89], v[78:79], v[62:63], v[88:89] op_sel:[1,1,0] op_sel_hi:[1,0,1] neg_lo:[0,1,0]
    v_pk_fma_f32 v[90:91], v[80:81], v[62:63], v[90:91] op_sel:[1,1,0] op_sel_hi:[1,0,1] neg_lo:[0,1,0]
    v_pk_fma_f32 v[92:93], v[82:83], v[62:63], v[92:93] op_sel:[1,1,0] op_sel_hi:[1,0,1] neg_lo:[0,1,0]
    v_pk_fma_f32 v[94:95], v[84:85], v[62:63], v[94:95] op_sel:[1,1,0] op_sel_hi:[1,0,1] neg_lo:[0,1,0]
    v_cvt_pk_bf16_f32 v96, v88, v89
    ds_write_b32 v49, v96 offset:15232
    v_cvt_pk_bf16_f32 v97, v90, v91
    ds_write_b32 v49, v97 offset:15504
    v_cvt_pk_bf16_f32 v98, v92, v93
    ds_write_b32 v49, v98 offset:15776
    v_cvt_pk_bf16_f32 v99, v94, v95
    ds_write_b32 v49, v99 offset:16048
    v_pk_mul_f32 v[78:79], v[88:89], v[62:63] op_sel_hi:[0,1]
    v_pk_mul_f32 v[80:81], v[90:91], v[62:63] op_sel_hi:[0,1]
    v_pk_mul_f32 v[82:83], v[92:93], v[62:63] op_sel_hi:[0,1]
    v_pk_mul_f32 v[84:85], v[94:95], v[62:63] op_sel_hi:[0,1]
    v_pk_fma_f32 v[78:79], v[88:89], v[62:63], v[78:79] op_sel:[1,1,0] op_sel_hi:[1,0,1] neg_lo:[0,1,0]
    v_pk_fma_f32 v[80:81], v[90:91], v[62:63], v[80:81] op_sel:[1,1,0] op_sel_hi:[1,0,1] neg_lo:[0,1,0]
    v_pk_fma_f32 v[82:83], v[92:93], v[62:63], v[82:83] op_sel:[1,1,0] op_sel_hi:[1,0,1] neg_lo:[0,1,0]
    v_pk_fma_f32 v[84:85], v[94:95], v[62:63], v[84:85] op_sel:[1,1,0] op_sel_hi:[1,0,1] neg_lo:[0,1,0]
    v_cvt_pk_bf16_f32 v96, v78, v79
    ds_write_b32 v49, v96 offset:16320
    v_cvt_pk_bf16_f32 v97, v80, v81
    ds_write_b32 v49, v97 offset:16592
    v_cvt_pk_bf16_f32 v98, v82, v83
    ds_write_b32 v49, v98 offset:16864
    v_cvt_pk_bf16_f32 v99, v84, v85
    ds_write_b32 v49, v99 offset:17136
    v_pk_mul_f32 v[72:73], v[70:71], v[68:69] op_sel_hi:[0,1]
    v_pk_fma_f32 v[72:73], v[70:71], v[68:69], v[72:73] op_sel:[1,1,0] op_sel_hi:[1,0,1] neg_lo:[0,1,0]
    v_cvt_pk_bf16_f32 v96, v72, -v73
    ds_write_b32 v49, v96 offset:1088
    ds_write_b32 v49, v96 offset:1360
    v_pk_mul_f32 v[76:77], v[72:73], v[54:55] op_sel_hi:[0,1]
    v_pk_mul_f32 v[78:79], v[72:73], v[56:57] op_sel_hi:[0,1]
    v_pk_mul_f32 v[80:81], v[72:73], v[58:59] op_sel_hi:[0,1]
    v_pk_mul_f32 v[74:75], v[72:73], v[68:69] op_sel_hi:[0,1]
    v_pk_fma_f32 v[76:77], v[72:73], v[54:55], v[76:77] op_sel:[1,1,0] op_sel_hi:[1,0,1] neg_lo:[0,1,0]
    v_pk_fma_f32 v[78:79], v[72:73], v[56:57], v[78:79] op_sel:[1,1,0] op_sel_hi:[1,0,1] neg_lo:[0,1,0]
    v_pk_fma_f32 v[80:81], v[72:73], v[58:59], v[80:81] op_sel:[1,1,0] op_sel_hi:[1,0,1] neg_lo:[0,1,0]
    v_pk_fma_f32 v[74:75], v[72:73], v[68:69], v[74:75] op_sel:[1,1,0] op_sel_hi:[1,0,1] neg_lo:[0,1,0]
    v_cvt_pk_bf16_f32 v97, v76, -v77
    ds_write_b32 v49, v97 offset:1632
    v_cvt_pk_bf16_f32 v98, v78, -v79
    ds_write_b32 v49, v98 offset:1904
    ds_write_b32 v49, v98 offset:3264
    ds_write_b32 v49, v98 offset:3536
    v_cvt_pk_bf16_f32 v99, v80, -v81
    ds_write_b32 v49, v99 offset:4080
    v_pk_mul_f32 v[82:83], v[76:77], v[56:57] op_sel_hi:[0,1]
    v_pk_mul_f32 v[84:85], v[74:75], v[56:57] op_sel_hi:[0,1]
    v_pk_mul_f32 v[86:87], v[74:75], v[58:59] op_sel_hi:[0,1]
    v_pk_mul_f32 v[72:73], v[74:75], v[68:69] op_sel_hi:[0,1]
    v_pk_fma_f32 v[82:83], v[76:77], v[56:57], v[82:83] op_sel:[1,1,0] op_sel_hi:[1,0,1] neg_lo:[0,1,0]
    v_pk_fma_f32 v[84:85], v[74:75], v[56:57], v[84:85] op_sel:[1,1,0] op_sel_hi:[1,0,1] neg_lo:[0,1,0]
    v_pk_fma_f32 v[86:87], v[74:75], v[58:59], v[86:87] op_sel:[1,1,0] op_sel_hi:[1,0,1] neg_lo:[0,1,0]
    v_pk_fma_f32 v[72:73], v[74:75], v[68:69], v[72:73] op_sel:[1,1,0] op_sel_hi:[1,0,1] neg_lo:[0,1,0]
    v_cvt_pk_bf16_f32 v96, v82, -v83
    ds_write_b32 v49, v96 offset:3808
    v_cvt_pk_bf16_f32 v97, v74, -v75
    ds_write_b32 v49, v97 offset:4352
    v_cvt_pk_bf16_f32 v98, v84, -v85
    ds_write_b32 v49, v98 offset:4624
    v_cvt_pk_bf16_f32 v99, v86, -v87
    ds_write_b32 v49, v99 offset:4896
    v_pk_mul_f32 v[76:77], v[72:73], v[56:57] op_sel_hi:[0,1]
    v_pk_mul_f32 v[78:79], v[72:73], v[58:59] op_sel_hi:[0,1]
    v_pk_mul_f32 v[74:75], v[72:73], v[68:69] op_sel_hi:[0,1]
    v_pk_fma_f32 v[76:77], v[72:73], v[56:57], v[76:77] op_sel:[1,1,0] op_sel_hi:[1,0,1] neg_lo:[0,1,0]
    v_pk_fma_f32 v[78:79], v[72:73], v[58:59], v[78:79] op_sel:[1,1,0] op_sel_hi:[1,0,1] neg_lo:[0,1,0]
    v_pk_fma_f32 v[74:75], v[72:73], v[68:69], v[74:75] op_sel:[1,1,0] op_sel_hi:[1,0,1] neg_lo:[0,1,0]
    v_cvt_pk_bf16_f32 v96, v72, -v73
    ds_write_b32 v49, v96 offset:5440
    v_cvt_pk_bf16_f32 v97, v76, -v77
    ds_write_b32 v49, v97 offset:5712
    v_cvt_pk_bf16_f32 v98, v78, -v79
    ds_write_b32 v49, v98 offset:5984
    v_pk_mul_f32 v[80:81], v[74:75], v[58:59] op_sel_hi:[0,1]
    v_pk_mul_f32 v[72:73], v[74:75], v[68:69] op_sel_hi:[0,1]
    v_pk_fma_f32 v[80:81], v[74:75], v[58:59], v[80:81] op_sel:[1,1,0] op_sel_hi:[1,0,1] neg_lo:[0,1,0]
    v_pk_fma_f32 v[72:73], v[74:75], v[68:69], v[72:73] op_sel:[1,1,0] op_sel_hi:[1,0,1] neg_lo:[0,1,0]
    v_cvt_pk_bf16_f32 v99, v74, -v75
    ds_write_b32 v49, v99 offset:5168
    v_cvt_pk_bf16_f32 v96, v80, -v81
    ds_write_b32 v49, v96 offset:6528
    v_pk_mul_f32 v[82:83], v[72:73], v[58:59] op_sel_hi:[0,1]
    v_pk_mul_f32 v[74:75], v[72:73], v[68:69] op_sel_hi:[0,1]
    v_pk_fma_f32 v[82:83], v[72:73], v[58:59], v[82:83] op_sel:[1,1,0] op_sel_hi:[1,0,1] neg_lo:[0,1,0]
    v_pk_fma_f32 v[74:75], v[72:73], v[68:69], v[74:75] op_sel:[1,1,0] op_sel_hi:[1,0,1] neg_lo:[0,1,0]
    v_cvt_pk_bf16_f32 v97, v72, -v73
    ds_write_b32 v49, v97 offset:6256
    v_cvt_pk_bf16_f32 v98, v82, -v83
    ds_write_b32 v49, v98 offset:7616
    v_pk_mul_f32 v[84:85], v[74:75], v[58:59] op_sel_hi:[0,1]
    v_pk_mul_f32 v[72:73], v[74:75], v[68:69] op_sel_hi:[0,1]
    v_pk_fma_f32 v[84:85], v[74:75], v[58:59], v[84:85] op_sel:[1,1,0] op_sel_hi:[1,0,1] neg_lo:[0,1,0]
    v_pk_fma_f32 v[72:73], v[74:75], v[68:69], v[72:73] op_sel:[1,1,0] op_sel_hi:[1,0,1] neg_lo:[0,1,0]
    v_cvt_pk_bf16_f32 v99, v74, -v75
    ds_write_b32 v49, v99 offset:6800
    v_cvt_pk_bf16_f32 v96, v84, -v85
    ds_write_b32 v49, v96 offset:7072
    v_pk_mul_f32 v[86:87], v[72:73], v[58:59] op_sel_hi:[0,1]
    v_pk_fma_f32 v[86:87], v[72:73], v[58:59], v[86:87] op_sel:[1,1,0] op_sel_hi:[1,0,1] neg_lo:[0,1,0]
    v_cvt_pk_bf16_f32 v97, v72, -v73
    ds_write_b32 v49, v97 offset:7888
    v_cvt_pk_bf16_f32 v98, v86, -v87
    ds_write_b32 v49, v98 offset:8160
    s_waitcnt lgkmcnt(0)
    ds_read_b128 v[100:103], v50 offset:0
    ds_read_b128 v[132:135], v50 offset:8704
    ds_read_b128 v[104:107], v50 offset:32
    ds_read_b128 v[136:139], v50 offset:8736
    ds_read_b128 v[108:111], v50 offset:64
    ds_read_b128 v[140:143], v50 offset:8768
    ds_read_b128 v[112:115], v50 offset:96
    ds_read_b128 v[144:147], v50 offset:8800
    ds_read_b128 v[116:119], v50 offset:128
    ds_read_b128 v[148:151], v50 offset:8832
    ds_read_b128 v[120:123], v50 offset:160
    ds_read_b128 v[152:155], v50 offset:8864
    ds_read_b128 v[124:127], v50 offset:192
    ds_read_b128 v[156:159], v50 offset:8896
    s_waitcnt lgkmcnt(12)
    v_mfma_f32_32x32x16_bf16 v[164:179], v[100:103], v[132:135], 0
    ds_read_b128 v[128:131], v50 offset:224
    ds_read_b128 v[160:163], v50 offset:8928
    s_waitcnt lgkmcnt(12)
    v_mfma_f32_32x32x16_bf16 v[164:179], v[104:107], v[136:139], v[164:179]
    s_waitcnt lgkmcnt(10)
    v_mfma_f32_32x32x16_bf16 v[164:179], v[108:111], v[140:143], v[164:179]
    s_waitcnt lgkmcnt(8)
    v_mfma_f32_32x32x16_bf16 v[164:179], v[112:115], v[144:147], v[164:179]
    s_waitcnt lgkmcnt(6)
    v_mfma_f32_32x32x16_bf16 v[164:179], v[116:119], v[148:151], v[164:179]
    s_waitcnt lgkmcnt(4)
    v_mfma_f32_32x32x16_bf16 v[164:179], v[120:123], v[152:155], v[164:179]
    s_waitcnt lgkmcnt(2)
    v_mfma_f32_32x32x16_bf16 v[164:179], v[124:127], v[156:159], v[164:179]
    s_waitcnt lgkmcnt(0)
    v_mfma_f32_32x32x16_bf16 v[164:179], v[128:131], v[160:163], v[164:179]
    v_mov_b32 v253, 1
    s_lshl_b32 s46, s52, 2
    s_add_u32 s46, s46, 156672
    v_mov_b32 v254, s46
    s_cmp_eq_u32 s53, 1
    s_cbranch_scc1 LAh_11
    s_nop 5
    ds_write_b128 v224, v[164:167] offset:0
    ds_write_b128 v224, v[168:171] offset:1024
    ds_write_b128 v224, v[172:175] offset:2048
    ds_write_b128 v224, v[176:179] offset:3072
    s_waitcnt lgkmcnt(0)
    ds_write_b32 v254, v253
    buffer_load_dwordx2 v[28:29], v9, s[36:39], 0 offen
    buffer_load_dwordx2 v[30:31], v10, s[36:39], 0 offen offset:0
    buffer_load_dwordx2 v[32:33], v10, s[36:39], 0 offen offset:1024
    buffer_load_dwordx2 v[34:35], v10, s[36:39], 0 offen offset:2048
    buffer_load_dwordx2 v[36:37], v10, s[36:39], 0 offen offset:3072
    buffer_load_dwordx2 v[38:39], v11, s[36:39], 0 offen offset:0
    buffer_load_dwordx2 v[40:41], v11, s[36:39], 0 offen offset:1024
    buffer_load_dwordx2 v[42:43], v11, s[36:39], 0 offen offset:2048
    buffer_load_dwordx2 v[44:45], v11, s[36:39], 0 offen offset:3072
    s_mov_b32 s46, 0x05040100
    s_mov_b32 s47, 0x07060302
    v_mov_b32 v3, 156688
Lsp_13:
    ds_read_b128 v[144:147], v3
    s_waitcnt lgkmcnt(0)
    v_and_b32 v144, v144, v145
    v_and_b32 v146, v146, v147
    v_and_b32 v144, v144, v146
    s_nop 0
    v_readfirstlane_b32 s49, v144
    s_nop 0
    s_cmp_eq_u32 s49, 1
    s_cbranch_scc0 Lsp_13
    v_and_b32 v3, 7, v1
    v_mul_u32_u24 v3, 4736, v3
    v_add_u32 v3, 70656, v3
    ds_write_b128 v3, v[240:243]
    s_waitcnt vmcnt(0)
    v_perm_b32 v112, v30, v28, s46
    v_perm_b32 v113, v34, v32, s46
    v_perm_b32 v114, v38, v36, s46
    v_perm_b32 v115, v42, v40, s46
    ds_write_b128 v230, v[112:115] offset:0
    v_perm_b32 v116, v32, v30, s46
    v_perm_b32 v117, v36, v34, s46
    v_perm_b32 v118, v40, v38, s46
    v_perm_b32 v119, v44, v42, s46
    ds_write_b128 v230, v[116:119] offset:4736
    v_perm_b32 v120, v30, v28, s47
    v_perm_b32 v121, v34, v32, s47
    v_perm_b32 v122, v38, v36, s47
    v_perm_b32 v123, v42, v40, s47
    ds_write_b128 v230, v[120:123] offset:9472
    v_perm_b32 v124, v32, v30, s47
    v_perm_b32 v125, v36, v34, s47
    v_perm_b32 v126, v40, v38, s47
    v_perm_b32 v127, v44, v42, s47
    ds_write_b128 v230, v[124:127] offset:14208
    v_perm_b32 v128, v31, v29, s46
    v_perm_b32 v129, v35, v33, s46
    v_perm_b32 v130, v39, v37, s46
    v_perm_b32 v131, v43, v41, s46
    ds_write_b128 v230, v[128:131] offset:18944
    v_perm_b32 v132, v33, v31, s46
    v_perm_b32 v133, v37, v35, s46
    v_perm_b32 v134, v41, v39, s46
    v_perm_b32 v135, v45, v43, s46
    ds_write_b128 v230, v[132:135] offset:23680
    v_perm_b32 v136, v31, v29, s47
    v_perm_b32 v137, v35, v33, s47
    v_perm_b32 v138, v39, v37, s47
    v_perm_b32 v139, v43, v41, s47
    ds_write_b128 v230, v[136:139] offset:28416
    v_perm_b32 v140, v33, v31, s47
    v_perm_b32 v141, v37, v35, s47
    v_perm_b32 v142, v41, v39, s47
    v_perm_b32 v143, v45, v43, s47
    ds_write_b128 v230, v[140:143] offset:33152
    s_branch LAh_12
LAh_11:
    ds_write_b32 v254, v253 offset:16
Lsq_14:
    ds_read_b32 v144, v254
    s_waitcnt lgkmcnt(0)
    v_readfirstlane_b32 s49, v144
    s_nop 0
    s_cmp_eq_u32 s49, 1
    s_cbranch_scc0 Lsq_14
    ds_read_b128 v[112:115], v224 offset:0
    ds_read_b128 v[116:119], v224 offset:1024
    ds_read_b128 v[120:123], v224 offset:2048
    ds_read_b128 v[124:127], v224 offset:3072
    v_lshlrev_b32 v3, 2, v1
    v_add_u32 v3, s68, v3
    ds_write_b32 v3, v240 offset:4112
    ds_write_b32 v3, v240 offset:8516
    ds_write_b32 v3, v240 offset:12936
    ds_write_b32 v3, v240 offset:17356
    s_waitcnt lgkmcnt(4)
    v_add_f32 v164, v164, v112
    v_add_f32 v165, v165, v113
    v_add_f32 v166, v166, v114
    v_add_f32 v167, v167, v115
    v_add_f32 v168, v168, v116
    v_add_f32 v169, v169, v117
    v_add_f32 v170, v170, v118
    v_add_f32 v171, v171, v119
    v_add_f32 v172, v172, v120
    v_add_f32 v173, v173, v121
    v_add_f32 v174, v174, v122
    v_add_f32 v175, v175, v123
    v_add_f32 v176, v176, v124
    v_add_f32 v177, v177, v125
    v_add_f32 v178, v178, v126
    v_add_f32 v164, v164, v51
    v_cvt_pk_bf16_f32 v112, v171, v170
    v_cvt_pk_bf16_f32 v113, v169, v168
    v_cvt_pk_bf16_f32 v114, v167, v166
    v_cvt_pk_bf16_f32 v115, v165, v164
    v_cvt_pk_bf16_f32 v116, v174, v174
    v_cvt_pk_bf16_f32 v117, v173, v173
    v_cvt_pk_bf16_f32 v118, v173, v172
    v_cvt_pk_bf16_f32 v119, v172, v172
    v_cndmask_b32 v144, v175, v176, s[58:59]
    v_cvt_pk_bf16_f32 v120, v176, v176
    v_cvt_pk_bf16_f32 v121, v176, v144
    v_cvt_pk_bf16_f32 v122, v175, v175
    v_cvt_pk_bf16_f32 v123, v175, v175
    v_cndmask_b32 v144, v177, v178, s[58:59]
    v_cvt_pk_bf16_f32 v124, v178, v178
    v_cvt_pk_bf16_f32 v125, v178, v144
    v_cvt_pk_bf16_f32 v126, v177, v177
    v_cvt_pk_bf16_f32 v127, v177, v177
    ds_write_b128 v225, v[112:115] offset:3088
    v_cndmask_b32 v128, v112, v113, s[54:55]
    v_cndmask_b32 v129, v113, v114, s[54:55]
    v_cndmask_b32 v130, v114, v115, s[54:55]
    v_cndmask_b32 v131, v115, v112, s[54:55]
    v_cndmask_b32 v132, v128, v130, s[56:57]
    v_cndmask_b32 v133, v129, v131, s[56:57]
    v_cndmask_b32 v134, v130, v128, s[56:57]
    v_cndmask_b32 v135, v131, v129, s[56:57]
    ds_write_b32 v226, v132 offset:7492
    ds_write_b32 v227, v133 offset:7492
    ds_write_b32 v228, v134 offset:7492
    ds_write_b32 v229, v135 offset:7492
    ds_write_b32 v226, v132 offset:11912
    ds_write_b32 v227, v133 offset:11912
    ds_write_b32 v228, v134 offset:11912
    ds_write_b32 v229, v135 offset:11912
    ds_write_b32 v226, v132 offset:16332
    ds_write_b32 v227, v133 offset:16332
    ds_write_b32 v228, v134 offset:16332
    ds_write_b32 v229, v135 offset:16332
    ds_write_b128 v225, v[116:119] offset:2064
    v_cndmask_b32 v128, v116, v117, s[54:55]
    v_cndmask_b32 v129, v117, v118, s[54:55]
    v_cndmask_b32 v130, v118, v119, s[54:55]
    v_cndmask_b32 v131, v119, v116, s[54:55]
    v_cndmask_b32 v136, v128, v130, s[56:57]
    v_cndmask_b32 v137, v129, v131, s[56:57]
    v_cndmask_b32 v138, v130, v128, s[56:57]
    v_cndmask_b32 v139, v131, v129, s[56:57]
    ds_write_b32 v226, v136 offset:6468
    ds_write_b32 v227, v137 offset:6468
    ds_write_b32 v228, v138 offset:6468
    ds_write_b32 v229, v139 offset:6468
    ds_write_b32 v226, v136 offset:10888
    ds_write_b32 v227, v137 offset:10888
    ds_write_b32 v228, v138 offset:10888
    ds_write_b32 v229, v139 offset:10888
    ds_write_b32 v226, v136 offset:15308
    ds_write_b32 v227, v137 offset:15308
    ds_write_b32 v228, v138 offset:15308
    ds_write_b32 v229, v139 offset:15308
    ds_write_b128 v225, v[120:123] offset:1040
    v_cndmask_b32 v128, v120, v121, s[54:55]
    v_cndmask_b32 v129, v121, v122, s[54:55]
    v_cndmask_b32 v130, v122, v123, s[54:55]
    v_cndmask_b32 v131, v123, v120, s[54:55]
    v_cndmask_b32 v132, v128, v130, s[56:57]
    v_cndmask_b32 v133, v129, v131, s[56:57]
    v_cndmask_b32 v134, v130, v128, s[56:57]
    v_cndmask_b32 v135, v131, v129, s[56:57]
    ds_write_b32 v226, v132 offset:5444
    ds_write_b32 v227, v133 offset:5444
    ds_write_b32 v228, v134 offset:5444
    ds_write_b32 v229, v135 offset:5444
    ds_write_b32 v226, v132 offset:9864
    ds_write_b32 v227, v133 offset:9864
    ds_write_b32 v228, v134 offset:9864
    ds_write_b32 v229, v135 offset:9864
    ds_write_b32 v226, v132 offset:14284
    ds_write_b32 v227, v133 offset:14284
    ds_write_b32 v228, v134 offset:14284
    ds_write_b32 v229, v135 offset:14284
    ds_write_b128 v225, v[124:127] offset:16
    v_cndmask_b32 v128, v124, v125, s[54:55]
    v_cndmask_b32 v129, v125, v126, s[54:55]
    v_cndmask_b32 v130, v126, v127, s[54:55]
    v_cndmask_b32 v131, v127, v124, s[54:55]
    v_cndmask_b32 v136, v128, v130, s[56:57]
    v_cndmask_b32 v137, v129, v131, s[56:57]
    v_cndmask_b32 v138, v130, v128, s[56:57]
    v_cndmask_b32 v139, v131, v129, s[56:57]
    ds_write_b32 v226, v136 offset:4420
    ds_write_b32 v227, v137 offset:4420
    ds_write_b32 v228, v138 offset:4420
    ds_write_b32 v229, v139 offset:4420
    ds_write_b32 v226, v136 offset:8840
    ds_write_b32 v227, v137 offset:8840
    ds_write_b32 v228, v138 offset:8840
    ds_write_b32 v229, v139 offset:8840
    ds_write_b32 v226, v136 offset:13260
    ds_write_b32 v227, v137 offset:13260
    ds_write_b32 v228, v138 offset:13260
    ds_write_b32 v229, v139 offset:13260
LAh_12:
    s_waitcnt lgkmcnt(0)
    s_barrier
    s_cmp_eq_u32 s53, 1
    s_cbranch_scc0 Lpr_15
    s_setprio 1
Lpr_15:
    v_max_i32 v237, v232, v233
    ds_read_b128 v[112:115], v231 offset:2048
    ds_read_b128 v[120:123], v237 offset:0
    ds_read_b128 v[124:127], v232 offset:2304
    ds_read_b128 v[116:119], v231 offset:0
    v_max_i32 v238, v232, v234
    ds_read_b128 v[128:131], v231 offset:2080
    ds_read_b128 v[136:139], v238 offset:32
    ds_read_b128 v[140:143], v232 offset:2336
    ds_read_b128 v[132:135], v231 offset:32
    s_mov_b32 s49, 0
Lconv_16:
    v_max_i32 v237, v232, v235
    ds_read_b128 v[144:147], v231 offset:2112
    ds_read_b128 v[152:155], v237 offset:64
    ds_read_b128 v[156:159], v232 offset:2368
    ds_read_b128 v[148:151], v231 offset:64
    s_waitcnt lgkmcnt(8)
    v_mfma_f32_32x32x16_bf16 v[192:207], v[112:115], v[120:123], v[192:207]
    v_mfma_f32_32x32x16_bf16 v[208:223], v[112:115], v[124:127], v[208:223]
    v_mfma_f32_32x32x16_bf16 v[208:223], v[116:119], v[120:123], v[208:223]
    v_max_i32 v238, v232, v236
    ds_read_b128 v[160:163], v231 offset:2144
    ds_read_b128 v[168:171], v238 offset:96
    ds_read_b128 v[172:175], v232 offset:2400
    ds_read_b128 v[164:167], v231 offset:96
    s_waitcnt lgkmcnt(8)
    v_mfma_f32_32x32x16_bf16 v[192:207], v[128:131], v[136:139], v[192:207]
    v_mfma_f32_32x32x16_bf16 v[208:223], v[128:131], v[140:143], v[208:223]
    v_mfma_f32_32x32x16_bf16 v[208:223], v[132:135], v[136:139], v[208:223]
    v_add_u32 v231, 128, v231
    v_add_u32 v232, 144, v232
    v_max_i32 v237, v232, v233
    ds_read_b128 v[112:115], v231 offset:2048
    ds_read_b128 v[120:123], v237 offset:0
    ds_read_b128 v[124:127], v232 offset:2304
    ds_read_b128 v[116:119], v231 offset:0
    s_waitcnt lgkmcnt(8)
    v_mfma_f32_32x32x16_bf16 v[192:207], v[144:147], v[152:155], v[192:207]
    v_mfma_f32_32x32x16_bf16 v[208:223], v[144:147], v[156:159], v[208:223]
    v_mfma_f32_32x32x16_bf16 v[208:223], v[148:151], v[152:155], v[208:223]
    v_max_i32 v238, v232, v234
    ds_read_b128 v[128:131], v231 offset:2080
    ds_read_b128 v[136:139], v238 offset:32
    ds_read_b128 v[140:143], v232 offset:2336
    ds_read_b128 v[132:135], v231 offset:32
    s_waitcnt lgkmcnt(8)
    v_mfma_f32_32x32x16_bf16 v[192:207], v[160:163], v[168:171], v[192:207]
    v_mfma_f32_32x32x16_bf16 v[208:223], v[160:163], v[172:175], v[208:223]
    v_mfma_f32_32x32x16_bf16 v[208:223], v[164:167], v[168:171], v[208:223]
    s_add_u32 s49, s49, 1
    s_cmp_eq_u32 s49, 4
    s_cbranch_scc0 Lq_17
    s_setprio 0
Lq_17:
    s_cmp_lt_u32 s49, 8
    s_cbranch_scc1 Lconv_16
    s_waitcnt lgkmcnt(0)
    s_cmp_eq_u32 s53, 0
    s_cbranch_scc0 LAx_18
    s_nop 3
    ds_write_b128 v246, v[208:211] offset:0
    ds_write_b128 v246, v[212:215] offset:1024
    ds_write_b128 v246, v[216:219] offset:2048
    ds_write_b128 v246, v[220:223] offset:3072
    s_branch LAx_19
LAx_18:
    s_nop 1
    ds_write_b128 v246, v[192:195] offset:0
    ds_write_b128 v246, v[196:199] offset:1024
    ds_write_b128 v246, v[200:203] offset:2048
    ds_write_b128 v246, v[204:207] offset:3072
LAx_19:
    s_waitcnt lgkmcnt(0)
    s_barrier
    ds_read_b128 v[112:115], v247 offset:0
    ds_read_b128 v[116:119], v247 offset:1024
    ds_read_b128 v[120:123], v247 offset:2048
    ds_read_b128 v[124:127], v247 offset:3072
    s_cmp_eq_u32 s53, 0
    s_cbranch_scc0 LAx_20
    s_waitcnt lgkmcnt(0)
    v_add_f32 v112, v112, v192
    v_add_f32 v113, v113, v193
    v_add_f32 v114, v114, v194
    v_add_f32 v115, v115, v195
    v_add_f32 v116, v116, v196
    v_add_f32 v117, v117, v197
    v_add_f32 v118, v118, v198
    v_add_f32 v119, v119, v199
    v_add_f32 v120, v120, v200
    v_add_f32 v121, v121, v201
    v_add_f32 v122, v122, v202
    v_add_f32 v123, v123, v203
    v_add_f32 v124, v124, v204
    v_add_f32 v125, v125, v205
    v_add_f32 v126, v126, v206
    v_add_f32 v127, v127, v207
    s_branch LAx_21
LAx_20:
    s_waitcnt lgkmcnt(0)
    v_add_f32 v112, v112, v208
    v_add_f32 v113, v113, v209
    v_add_f32 v114, v114, v210
    v_add_f32 v115, v115, v211
    v_add_f32 v116, v116, v212
    v_add_f32 v117, v117, v213
    v_add_f32 v118, v118, v214
    v_add_f32 v119, v119, v215
    v_add_f32 v120, v120, v216
    v_add_f32 v121, v121, v217
    v_add_f32 v122, v122, v218
    v_add_f32 v123, v123, v219
    v_add_f32 v124, v124, v220
    v_add_f32 v125, v125, v221
    v_add_f32 v126, v126, v222
    v_add_f32 v127, v127, v223
LAx_21:
    v_cvt_pk_bf16_f32 v128, v112, v113
    ds_write_b16 v248, v128 offset:0
    ds_write_b16_d16_hi v248, v128 offset:16
    v_cvt_pk_bf16_f32 v129, v114, v115
    ds_write_b16 v248, v129 offset:32
    ds_write_b16_d16_hi v248, v129 offset:48
    v_cvt_pk_bf16_f32 v130, v116, v117
    ds_write_b16 v248, v130 offset:128
    ds_write_b16_d16_hi v248, v130 offset:144
    v_cvt_pk_bf16_f32 v131, v118, v119
    ds_write_b16 v248, v131 offset:160
    ds_write_b16_d16_hi v248, v131 offset:176
    v_cvt_pk_bf16_f32 v128, v120, v121
    ds_write_b16 v248, v128 offset:256
    ds_write_b16_d16_hi v248, v128 offset:272
    v_cvt_pk_bf16_f32 v129, v122, v123
    ds_write_b16 v248, v129 offset:288
    ds_write_b16_d16_hi v248, v129 offset:304
    v_cvt_pk_bf16_f32 v130, v124, v125
    ds_write_b16 v248, v130 offset:384
    ds_write_b16_d16_hi v248, v130 offset:400
    v_cvt_pk_bf16_f32 v131, v126, v127
    ds_write_b16 v248, v131 offset:416
    ds_write_b16_d16_hi v248, v131 offset:432
    s_waitcnt lgkmcnt(0)
    s_barrier
    ds_read_b128 v[132:135], v249
    ds_read_b128 v[136:139], v249 offset:16
    s_mov_b32 s50, 4096
    s_waitcnt lgkmcnt(1)
    buffer_store_dwordx2 v[132:133], v250, s[40:43], 0 offen offset:0
    buffer_store_dwordx2 v[134:135], v250, s[40:43], 0 offen offset:2048
    s_waitcnt lgkmcnt(0)
    buffer_store_dwordx2 v[136:137], v250, s[40:43], s50 offen offset:0
    buffer_store_dwordx2 v[138:139], v250, s[40:43], s50 offen offset:2048
    s_waitcnt vmcnt(0)
    s_endpgm
LF_B:
    s_and_b32 s3, s6, 3
    s_lshl_b32 s3, s3, 2
    s_bfe_u32 s4, s6, 0x20003
    s_add_u32 s3, s3, s4
    s_bfe_u32 s4, s6, 0x10002
    s_lshl_b32 s4, s4, 2
    s_bfe_u32 s5, s6, 0x20005
    s_add_u32 s4, s4, s5
    s_load_dwordx8 s[16:23], s[0:1], 72
    s_load_dwordx4 s[24:27], s[0:1], 104
    v_and_b32 v1, 63, v0
    v_lshrrev_b32 v2, 6, v0
    s_nop 0
    v_readfirstlane_b32 s44, v2
    s_nop 0
    s_and_b32 s45, s44, 3
    s_lshr_b32 s46, s44, 2
    s_add_u32 s58, s4, s3
    s_and_b32 s58, s58, 3
    s_lshl_b32 s58, s58, 1
    v_lshrrev_b32 v3, 3, v1
    v_and_b32 v4, 7, v1
    v_lshrrev_b32 v5, 1, v3
    v_xor_b32 v5, v5, v4
    s_lshl_b32 s47, s3, 7
    s_lshl_b32 s48, s44, 4
    s_add_u32 s47, s47, s48
    v_add_u32 v6, s47, v3
    v_lshlrev_b32 v6, 10, v6
    v_lshlrev_b32 v7, 4, v5
    v_add_u32 v7, v7, v6
    v_xor_b32 v5, 4, v5
    v_lshlrev_b32 v8, 4, v5
    v_add_u32 v8, v8, v6
    v_add_u32 v8, 8192, v8
    v_bfe_u32 v5, v3, 1, 1
    v_lshlrev_b32 v5, 2, v5
    v_xor_b32 v5, v5, v4
    v_lshlrev_b32 v5, 4, v5
    s_lshl_b32 s48, s44, 3
    v_add_u32 v6, s48, v3
    v_lshlrev_b32 v2, 10, v6
    v_mul_u32_u24 v6, 3072, v6
    s_lshl_b32 s48, s4, 7
    v_add3_u32 v9, v6, v5, s48
    v_add3_u32 v2, v2, v5, s48
    s_lshl_b32 s49, s44, 11
    s_lshl_b32 s50, s44, 10
    s_waitcnt lgkmcnt(0)
    s_mov_b32 s28, s16
    s_and_b32 s29, s17, 0xffff
    s_mov_b32 s30, 0x200000
    s_mov_b32 s31, 0x20000
    s_mov_b32 s32, s18
    s_and_b32 s33, s19, 0xffff
    s_mov_b32 s34, 0x180000
    s_mov_b32 s35, 0x20000
    s_add_u32 s59, s58, 0
    s_and_b32 s59, s59, 7
    s_lshl_b32 s68, s59, 7
    s_mul_i32 s69, s59, 196608
    s_add_u32 m0, s49, 0
    s_nop 0
    buffer_load_dwordx4 v7, s[28:31], s68 offen lds
    s_add_u32 m0, s49, 1024
    s_nop 0
    buffer_load_dwordx4 v8, s[28:31], s68 offen lds
    s_add_u32 s51, s69, 1024
    s_add_u32 m0, s50, 16384
    s_nop 0
    buffer_load_dwordx4 v9, s[32:35], s51 offen lds
    s_add_u32 s51, s69, 2048
    s_add_u32 m0, s50, 24576
    s_nop 0
    buffer_load_dwordx4 v9, s[32:35], s51 offen lds
    s_mov_b32 s36, s26
    s_and_b32 s37, s27, 0xffff
    s_mov_b32 s38, 0x10000000
    s_mov_b32 s39, 0x20000
    s_mov_b32 s40, s24
    s_and_b32 s41, s25, 0xffff
    s_mov_b32 s42, 0x100
    s_mov_b32 s43, 0x20000
    s_mov_b32 s60, s20
    s_and_b32 s61, s21, 0xffff
    s_mov_b32 s62, 0x80000
    s_mov_b32 s63, 0x20000
    s_mov_b32 s64, s22
    s_and_b32 s65, s23, 0xffff
    s_mov_b32 s66, 0x400000
    s_mov_b32 s67, 0x20000
    v_and_b32 v3, 31, v1
    v_lshrrev_b32 v4, 5, v1
    v_bfe_u32 v5, v1, 1, 3
    s_lshl_b32 s47, s45, 5
    v_add_u32 v6, s47, v3
    v_lshlrev_b32 v6, 7, v6
    v_add_u32 v10, 0, v4
    v_xor_b32 v10, v10, v5
    v_lshlrev_b32 v10, 4, v10
    v_add_u32 v10, v10, v6
    v_add_u32 v11, 2, v4
    v_xor_b32 v11, v11, v5
    v_lshlrev_b32 v11, 4, v11
    v_add_u32 v11, v11, v6
    v_add_u32 v12, 4, v4
    v_xor_b32 v12, v12, v5
    v_lshlrev_b32 v12, 4, v12
    v_add_u32 v12, v12, v6
    v_add_u32 v13, 6, v4
    v_xor_b32 v13, v13, v5
    v_lshlrev_b32 v13, 4, v13
    v_add_u32 v13, v13, v6
    v_bfe_u32 v3, v1, 2, 2
    v_lshlrev_b32 v5, 3, v4
    v_add_u32 v5, v5, v3
    v_lshlrev_b32 v14, 7, v5
    v_lshrrev_b32 v3, 1, v3
    v_xor_b32 v3, s46, v3
    v_lshlrev_b32 v3, 6, v3
    v_add_u32 v14, v14, v3
    v_bfe_u32 v3, v1, 4, 1
    v_lshlrev_b32 v3, 5, v3
    v_and_b32 v5, 3, v1
    v_lshlrev_b32 v5, 3, v5
    v_add3_u32 v14, v14, v3, v5
    v_mov_b32 v52, 0
    v_mov_b32 v68, 0
    v_mov_b32 v84, 0
    v_mov_b32 v53, 0
    v_mov_b32 v69, 0
    v_mov_b32 v85, 0
    v_mov_b32 v54, 0
    v_mov_b32 v70, 0
    v_mov_b32 v86, 0
    v_mov_b32 v55, 0
    v_mov_b32 v71, 0
    v_mov_b32 v87, 0
    v_mov_b32 v56, 0
    v_mov_b32 v72, 0
    v_mov_b32 v88, 0
    v_mov_b32 v57, 0
    v_mov_b32 v73, 0
    v_mov_b32 v89, 0
    v_mov_b32 v58, 0
    v_mov_b32 v74, 0
    v_mov_b32 v90, 0
    v_mov_b32 v59, 0
    v_mov_b32 v75, 0
    v_mov_b32 v91, 0
    v_mov_b32 v60, 0
    v_mov_b32 v76, 0
    v_mov_b32 v92, 0
    v_mov_b32 v61, 0
    v_mov_b32 v77, 0
    v_mov_b32 v93, 0
    v_mov_b32 v62, 0
    v_mov_b32 v78, 0
    v_mov_b32 v94, 0
    v_mov_b32 v63, 0
    v_mov_b32 v79, 0
    v_mov_b32 v95, 0
    v_mov_b32 v64, 0
    v_mov_b32 v80, 0
    v_mov_b32 v96, 0
    v_mov_b32 v65, 0
    v_mov_b32 v81, 0
    v_mov_b32 v97, 0
    v_mov_b32 v66, 0
    v_mov_b32 v82, 0
    v_mov_b32 v98, 0
    v_mov_b32 v67, 0
    v_mov_b32 v83, 0
    v_mov_b32 v99, 0
    v_bfe_u32 v3, v1, 4, 1
    v_cmp_eq_u32 s[52:53], 1, v3
    s_lshl_b32 s47, s44, 8
    s_add_u32 s47, s47, 49152
    v_lshlrev_b32 v4, 2, v1
    v_add_u32 v121, s47, v4
    s_lshl_b32 s47, s44, 11
    s_add_u32 s47, s47, 32768
    v_lshlrev_b32 v120, 5, v1
    v_add_u32 v120, s47, v120
    s_bfe_u32 s54, s44, 0x10001
    s_and_b32 s55, s44, 1
    s_lshl_b32 s47, s55, 5
    s_lshl_b32 s48, s54, 4
    s_add_u32 s47, s47, s48
    s_lshl_b32 s47, s47, 5
    s_lshl_b32 s48, s46, 13
    s_add_u32 s47, s47, s48
    s_add_u32 s47, s47, 32768
    v_add_u32 v122, s47, v4
    v_and_b32 v123, 31, v1
    v_lshlrev_b32 v123, 2, v123
    s_lshl_b32 s48, s46, 10
    s_add_u32 s48, s48, 49152
    v_add_u32 v123, s48, v123
    s_lshl_b32 s47, s4, 2
    s_lshl_b32 s48, s46, 1
    s_add_u32 s47, s47, s48
    s_add_u32 s48, s47, s54
    s_lshl_b32 s48, s48, 10
    s_lshl_b32 s51, s55, 9
    s_add_u32 s48, s48, s51
    v_add_u32 v125, s48, v4
    v_bfe_u32 v126, v1, 4, 1
    v_add_u32 v126, s47, v126
    v_lshlrev_b32 v126, 6, v126
    v_bfe_u32 v5, v1, 2, 1
    v_lshlrev_b32 v5, 5, v5
    v_add_u32 v126, v126, v5
    v_and_b32 v5, 3, v1
    v_bfe_u32 v6, v1, 3, 1
    v_lshlrev_b32 v6, 2, v6
    v_add_u32 v5, v5, v6
    v_lshlrev_b32 v5, 2, v5
    v_add_u32 v126, v126, v5
    v_add_u32 v126, 32768, v126
    s_lshl_b32 s47, s47, 6
    s_lshl_b32 s48, s3, 2
    s_add_u32 s47, s47, s48
    s_add_u32 s47, s47, s45
    s_lshl_b32 s47, s47, 10
    s_add_u32 s47, s47, 1048576
    v_lshlrev_b32 v124, 4, v1
    v_add_u32 v124, s47, v124
    s_waitcnt vmcnt(0)
    s_barrier
    s_add_u32 s59, s58, 1
    s_and_b32 s59, s59, 7
    s_lshl_b32 s68, s59, 7
    s_mul_i32 s69, s59, 196608
    s_add_u32 m0, s49, 32768
    s_nop 0
    buffer_load_dwordx4 v7, s[28:31], s68 offen lds
    s_add_u32 m0, s49, 33792
    s_nop 0
    buffer_load_dwordx4 v8, s[28:31], s68 offen lds
    s_add_u32 s51, s69, 1024
    s_add_u32 m0, s50, 49152
    s_nop 0
    buffer_load_dwordx4 v9, s[32:35], s51 offen lds
    s_add_u32 s51, s69, 2048
    s_add_u32 m0, s50, 57344
    s_nop 0
    buffer_load_dwordx4 v9, s[32:35], s51 offen lds
    v_add_u32 v15, 0, v10
    v_add_u32 v16, 0, v11
    v_add_u32 v17, 0, v12
    v_add_u32 v18, 0, v13
    v_add_u32 v19, 0, v14
    ds_read_b128 v[128:131], v15
    ds_read_b64_tr_b16 v[20:21], v19 offset:16384
    ds_read_b64_tr_b16 v[22:23], v19 offset:16896
    ds_read_b64_tr_b16 v[24:25], v19 offset:24576
    ds_read_b64_tr_b16 v[26:27], v19 offset:25088
    ds_read_b128 v[132:135], v16
    ds_read_b64_tr_b16 v[28:29], v19 offset:18432
    ds_read_b64_tr_b16 v[30:31], v19 offset:18944
    ds_read_b64_tr_b16 v[32:33], v19 offset:26624
    ds_read_b64_tr_b16 v[34:35], v19 offset:27136
    s_waitcnt lgkmcnt(5)
    s_setprio 1
    v_mfma_f32_32x32x16_bf16 v[52:67], v[128:131], v[20:23], v[52:67]
    v_mfma_f32_32x32x16_bf16 v[68:83], v[128:131], v[24:27], v[68:83]
    s_setprio 0
    ds_read_b128 v[136:139], v17
    ds_read_b64_tr_b16 v[36:37], v19 offset:20480
    ds_read_b64_tr_b16 v[38:39], v19 offset:20992
    ds_read_b64_tr_b16 v[40:41], v19 offset:28672
    ds_read_b64_tr_b16 v[42:43], v19 offset:29184
    s_add_u32 s59, s58, 2
    s_and_b32 s59, s59, 7
    s_lshl_b32 s68, s59, 7
    s_mul_i32 s69, s59, 196608
    s_add_u32 m0, s49, 65536
    s_nop 0
    buffer_load_dwordx4 v7, s[28:31], s68 offen lds
    s_add_u32 m0, s49, 66560
    s_nop 0
    buffer_load_dwordx4 v8, s[28:31], s68 offen lds
    s_waitcnt lgkmcnt(5)
    v_mfma_f32_32x32x16_bf16 v[52:67], v[132:135], v[28:31], v[52:67]
    ds_read_b128 v[140:143], v18
    ds_read_b64_tr_b16 v[44:45], v19 offset:22528
    ds_read_b64_tr_b16 v[46:47], v19 offset:23040
    ds_read_b64_tr_b16 v[48:49], v19 offset:30720
    ds_read_b64_tr_b16 v[50:51], v19 offset:31232
    s_add_u32 s51, s69, 1024
    s_add_u32 m0, s50, 81920
    s_nop 0
    buffer_load_dwordx4 v9, s[32:35], s51 offen lds
    s_add_u32 s51, s69, 2048
    s_add_u32 m0, s50, 90112
    s_nop 0
    buffer_load_dwordx4 v9, s[32:35], s51 offen lds
    s_waitcnt vmcnt(4) lgkmcnt(5)
    v_mfma_f32_32x32x16_bf16 v[68:83], v[132:135], v[32:35], v[68:83]
    s_barrier
    s_setprio 1
    v_mfma_f32_32x32x16_bf16 v[52:67], v[136:139], v[36:39], v[52:67]
    v_mfma_f32_32x32x16_bf16 v[68:83], v[136:139], v[40:43], v[68:83]
    s_setprio 0
    v_add_u32 v15, 32768, v10
    v_add_u32 v16, 32768, v11
    v_add_u32 v17, 32768, v12
    v_add_u32 v18, 32768, v13
    v_add_u32 v19, 32768, v14
    ds_read_b128 v[144:147], v15
    ds_read_b64_tr_b16 v[20:21], v19 offset:16384
    ds_read_b64_tr_b16 v[22:23], v19 offset:16896
    ds_read_b64_tr_b16 v[24:25], v19 offset:24576
    ds_read_b64_tr_b16 v[26:27], v19 offset:25088
    s_add_u32 s59, s58, 3
    s_and_b32 s59, s59, 7
    s_lshl_b32 s68, s59, 7
    s_mul_i32 s69, s59, 196608
    s_add_u32 m0, s49, 98304
    s_nop 0
    buffer_load_dwordx4 v7, s[28:31], s68 offen lds
    s_add_u32 m0, s49, 99328
    s_nop 0
    buffer_load_dwordx4 v8, s[28:31], s68 offen lds
    s_waitcnt lgkmcnt(5)
    s_setprio 1
    v_mfma_f32_32x32x16_bf16 v[52:67], v[140:143], v[44:47], v[52:67]
    v_mfma_f32_32x32x16_bf16 v[68:83], v[140:143], v[48:51], v[68:83]
    s_setprio 0
    ds_read_b128 v[148:151], v16
    ds_read_b64_tr_b16 v[28:29], v19 offset:18432
    ds_read_b64_tr_b16 v[30:31], v19 offset:18944
    ds_read_b64_tr_b16 v[32:33], v19 offset:26624
    ds_read_b64_tr_b16 v[34:35], v19 offset:27136
    s_add_u32 s51, s69, 1024
    s_add_u32 m0, s50, 114688
    s_nop 0
    buffer_load_dwordx4 v9, s[32:35], s51 offen lds
    s_add_u32 s51, s69, 2048
    s_add_u32 m0, s50, 122880
    s_nop 0
    buffer_load_dwordx4 v9, s[32:35], s51 offen lds
    s_waitcnt lgkmcnt(5)
    s_setprio 1
    v_mfma_f32_32x32x16_bf16 v[52:67], v[144:147], v[20:23], v[52:67]
    v_mfma_f32_32x32x16_bf16 v[68:83], v[144:147], v[24:27], v[68:83]
    s_setprio 0
    ds_read_b128 v[152:155], v17
    ds_read_b64_tr_b16 v[36:37], v19 offset:20480
    ds_read_b64_tr_b16 v[38:39], v19 offset:20992
    ds_read_b64_tr_b16 v[40:41], v19 offset:28672
    ds_read_b64_tr_b16 v[42:43], v19 offset:29184
    s_add_u32 s59, s58, 4
    s_and_b32 s59, s59, 7
    s_lshl_b32 s68, s59, 7
    s_mul_i32 s69, s59, 196608
    s_add_u32 m0, s49, 131072
    s_nop 0
    buffer_load_dwordx4 v7, s[28:31], s68 offen lds
    s_waitcnt lgkmcnt(5)
    v_mfma_f32_32x32x16_bf16 v[52:67], v[148:151], v[28:31], v[52:67]
    ds_read_b128 v[156:159], v18
    ds_read_b64_tr_b16 v[44:45], v19 offset:22528
    ds_read_b64_tr_b16 v[46:47], v19 offset:23040
    ds_read_b64_tr_b16 v[48:49], v19 offset:30720
    ds_read_b64_tr_b16 v[50:51], v19 offset:31232
    s_add_u32 m0, s49, 132096
    s_nop 0
    buffer_load_dwordx4 v8, s[28:31], s68 offen lds
    s_waitcnt vmcnt(6) lgkmcnt(5)
    v_mfma_f32_32x32x16_bf16 v[68:83], v[148:151], v[32:35], v[68:83]
    s_barrier
    s_setprio 1
    v_mfma_f32_32x32x16_bf16 v[52:67], v[152:155], v[36:39], v[52:67]
    v_mfma_f32_32x32x16_bf16 v[68:83], v[152:155], v[40:43], v[68:83]
    s_setprio 0
    v_add_u32 v15, 65536, v10
    v_add_u32 v16, 65536, v11
    v_add_u32 v17, 65536, v12
    v_add_u32 v18, 65536, v13
    v_add_u32 v19, 65536, v14
    ds_read_b128 v[160:163], v15
    ds_read_b64_tr_b16 v[20:21], v19 offset:16384
    ds_read_b64_tr_b16 v[22:23], v19 offset:16896
    ds_read_b64_tr_b16 v[24:25], v19 offset:24576
    ds_read_b64_tr_b16 v[26:27], v19 offset:25088
    s_add_u32 s51, s69, 1024
    s_add_u32 m0, s50, 147456
    s_nop 0
    buffer_load_dwordx4 v9, s[32:35], s51 offen lds
    s_waitcnt lgkmcnt(5)
    s_setprio 1
    v_mfma_f32_32x32x16_bf16 v[52:67], v[156:159], v[44:47], v[52:67]
    v_mfma_f32_32x32x16_bf16 v[68:83], v[156:159], v[48:51], v[68:83]
    s_setprio 0
    ds_read_b128 v[164:167], v16
    ds_read_b64_tr_b16 v[28:29], v19 offset:18432
    ds_read_b64_tr_b16 v[30:31], v19 offset:18944
    ds_read_b64_tr_b16 v[32:33], v19 offset:26624
    ds_read_b64_tr_b16 v[34:35], v19 offset:27136
    s_add_u32 s51, s69, 2048
    s_add_u32 m0, s50, 155648
    s_nop 0
    buffer_load_dwordx4 v9, s[32:35], s51 offen lds
    s_waitcnt lgkmcnt(5)
    s_setprio 1
    v_mfma_f32_32x32x16_bf16 v[52:67], v[160:163], v[20:23], v[52:67]
    v_mfma_f32_32x32x16_bf16 v[68:83], v[160:163], v[24:27], v[68:83]
    s_setprio 0
    ds_read_b128 v[168:171], v17
    ds_read_b64_tr_b16 v[36:37], v19 offset:20480
    ds_read_b64_tr_b16 v[38:39], v19 offset:20992
    ds_read_b64_tr_b16 v[40:41], v19 offset:28672
    ds_read_b64_tr_b16 v[42:43], v19 offset:29184
    s_add_u32 s59, s58, 5
    s_and_b32 s59, s59, 7
    s_lshl_b32 s68, s59, 7
    s_mul_i32 s69, s59, 196608
    s_add_u32 m0, s49, 0
    s_nop 0
    buffer_load_dwordx4 v7, s[28:31], s68 offen lds
    s_waitcnt lgkmcnt(5)
    v_mfma_f32_32x32x16_bf16 v[52:67], v[164:167], v[28:31], v[52:67]
    ds_read_b128 v[172:175], v18
    ds_read_b64_tr_b16 v[44:45], v19 offset:22528
    ds_read_b64_tr_b16 v[46:47], v19 offset:23040
    ds_read_b64_tr_b16 v[48:49], v19 offset:30720
    ds_read_b64_tr_b16 v[50:51], v19 offset:31232
    s_add_u32 m0, s49, 1024
    s_nop 0
    buffer_load_dwordx4 v8, s[28:31], s68 offen lds
    s_waitcnt vmcnt(6) lgkmcnt(5)
    v_mfma_f32_32x32x16_bf16 v[68:83], v[164:167], v[32:35], v[68:83]
    s_barrier
    s_setprio 1
    v_mfma_f32_32x32x16_bf16 v[52:67], v[168:171], v[36:39], v[52:67]
    v_mfma_f32_32x32x16_bf16 v[68:83], v[168:171], v[40:43], v[68:83]
    s_setprio 0
    v_add_u32 v15, 98304, v10
    v_add_u32 v16, 98304, v11
    v_add_u32 v17, 98304, v12
    v_add_u32 v18, 98304, v13
    v_add_u32 v19, 98304, v14
    ds_read_b128 v[176:179], v15
    ds_read_b64_tr_b16 v[20:21], v19 offset:16384
    ds_read_b64_tr_b16 v[22:23], v19 offset:16896
    ds_read_b64_tr_b16 v[24:25], v19 offset:24576
    ds_read_b64_tr_b16 v[26:27], v19 offset:25088
    s_add_u32 s51, s69, 1024
    s_add_u32 m0, s50, 16384
    s_nop 0
    buffer_load_dwordx4 v9, s[32:35], s51 offen lds
    s_waitcnt lgkmcnt(5)
    s_setprio 1
    v_mfma_f32_32x32x16_bf16 v[52:67], v[172:175], v[44:47], v[52:67]
    v_mfma_f32_32x32x16_bf16 v[68:83], v[172:175], v[48:51], v[68:83]
    s_setprio 0
    ds_read_b128 v[180:183], v16
    ds_read_b64_tr_b16 v[28:29], v19 offset:18432
    ds_read_b64_tr_b16 v[30:31], v19 offset:18944
    ds_read_b64_tr_b16 v[32:33], v19 offset:26624
    ds_read_b64_tr_b16 v[34:35], v19 offset:27136
    s_add_u32 s51, s69, 2048
    s_add_u32 m0, s50, 24576
    s_nop 0
    buffer_load_dwordx4 v9, s[32:35], s51 offen lds
    s_waitcnt lgkmcnt(5)
    s_setprio 1
    v_mfma_f32_32x32x16_bf16 v[52:67], v[176:179], v[20:23], v[52:67]
    v_mfma_f32_32x32x16_bf16 v[68:83], v[176:179], v[24:27], v[68:83]
    s_setprio 0
    ds_read_b128 v[184:187], v17
    ds_read_b64_tr_b16 v[36:37], v19 offset:20480
    ds_read_b64_tr_b16 v[38:39], v19 offset:20992
    ds_read_b64_tr_b16 v[40:41], v19 offset:28672
    ds_read_b64_tr_b16 v[42:43], v19 offset:29184
    s_add_u32 s59, s58, 6
    s_and_b32 s59, s59, 7
    s_lshl_b32 s68, s59, 7
    s_mul_i32 s69, s59, 196608
    s_add_u32 m0, s49, 32768
    s_nop 0
    buffer_load_dwordx4 v7, s[28:31], s68 offen lds
    s_waitcnt lgkmcnt(5)
    v_mfma_f32_32x32x16_bf16 v[52:67], v[180:183], v[28:31], v[52:67]
    ds_read_b128 v[188:191], v18
    ds_read_b64_tr_b16 v[44:45], v19 offset:22528
    ds_read_b64_tr_b16 v[46:47], v19 offset:23040
    ds_read_b64_tr_b16 v[48:49], v19 offset:30720
    ds_read_b64_tr_b16 v[50:51], v19 offset:31232
    s_add_u32 m0, s49, 33792
    s_nop 0
    buffer_load_dwordx4 v8, s[28:31], s68 offen lds
    s_waitcnt vmcnt(6) lgkmcnt(5)
    v_mfma_f32_32x32x16_bf16 v[68:83], v[180:183], v[32:35], v[68:83]
    s_barrier
    s_setprio 1
    v_mfma_f32_32x32x16_bf16 v[52:67], v[184:187], v[36:39], v[52:67]
    v_mfma_f32_32x32x16_bf16 v[68:83], v[184:187], v[40:43], v[68:83]
    s_setprio 0
    v_add_u32 v15, 131072, v10
    v_add_u32 v16, 131072, v11
    v_add_u32 v17, 131072, v12
    v_add_u32 v18, 131072, v13
    v_add_u32 v19, 131072, v14
    ds_read_b128 v[192:195], v15
    ds_read_b64_tr_b16 v[20:21], v19 offset:16384
    ds_read_b64_tr_b16 v[22:23], v19 offset:16896
    ds_read_b64_tr_b16 v[24:25], v19 offset:24576
    ds_read_b64_tr_b16 v[26:27], v19 offset:25088
    s_add_u32 s51, s69, 1024
    s_add_u32 m0, s50, 49152
    s_nop 0
    buffer_load_dwordx4 v9, s[32:35], s51 offen lds
    s_waitcnt lgkmcnt(5)
    s_setprio 1
    v_mfma_f32_32x32x16_bf16 v[52:67], v[188:191], v[44:47], v[52:67]
    v_mfma_f32_32x32x16_bf16 v[68:83], v[188:191], v[48:51], v[68:83]
    s_setprio 0
    ds_read_b128 v[196:199], v16
    ds_read_b64_tr_b16 v[28:29], v19 offset:18432
    ds_read_b64_tr_b16 v[30:31], v19 offset:18944
    ds_read_b64_tr_b16 v[32:33], v19 offset:26624
    ds_read_b64_tr_b16 v[34:35], v19 offset:27136
    s_add_u32 s51, s69, 2048
    s_add_u32 m0, s50, 57344
    s_nop 0
    buffer_load_dwordx4 v9, s[32:35], s51 offen lds
    s_waitcnt lgkmcnt(5)
    s_setprio 1
    v_mfma_f32_32x32x16_bf16 v[52:67], v[192:195], v[20:23], v[52:67]
    v_mfma_f32_32x32x16_bf16 v[68:83], v[192:195], v[24:27], v[68:83]
    s_setprio 0
    ds_read_b128 v[200:203], v17
    ds_read_b64_tr_b16 v[36:37], v19 offset:20480
    ds_read_b64_tr_b16 v[38:39], v19 offset:20992
    ds_read_b64_tr_b16 v[40:41], v19 offset:28672
    ds_read_b64_tr_b16 v[42:43], v19 offset:29184
    s_add_u32 s59, s58, 7
    s_and_b32 s59, s59, 7
    s_lshl_b32 s68, s59, 7
    s_mul_i32 s69, s59, 196608
    s_add_u32 m0, s49, 65536
    s_nop 0
    buffer_load_dwordx4 v7, s[28:31], s68 offen lds
    s_waitcnt lgkmcnt(5)
    v_mfma_f32_32x32x16_bf16 v[52:67], v[196:199], v[28:31], v[52:67]
    ds_read_b128 v[204:207], v18
    ds_read_b64_tr_b16 v[44:45], v19 offset:22528
    ds_read_b64_tr_b16 v[46:47], v19 offset:23040
    ds_read_b64_tr_b16 v[48:49], v19 offset:30720
    ds_read_b64_tr_b16 v[50:51], v19 offset:31232
    s_add_u32 m0, s49, 66560
    s_nop 0
    buffer_load_dwordx4 v8, s[28:31], s68 offen lds
    s_waitcnt vmcnt(6) lgkmcnt(5)
    v_mfma_f32_32x32x16_bf16 v[68:83], v[196:199], v[32:35], v[68:83]
    s_barrier
    s_setprio 1
    v_mfma_f32_32x32x16_bf16 v[52:67], v[200:203], v[36:39], v[52:67]
    v_mfma_f32_32x32x16_bf16 v[68:83], v[200:203], v[40:43], v[68:83]
    s_setprio 0
    v_add_u32 v15, 0, v10
    v_add_u32 v16, 0, v11
    v_add_u32 v17, 0, v12
    v_add_u32 v18, 0, v13
    v_add_u32 v19, 0, v14
    ds_read_b128 v[208:211], v15
    ds_read_b64_tr_b16 v[20:21], v19 offset:16384
    ds_read_b64_tr_b16 v[22:23], v19 offset:16896
    ds_read_b64_tr_b16 v[24:25], v19 offset:24576
    ds_read_b64_tr_b16 v[26:27], v19 offset:25088
    s_add_u32 s51, s69, 1024
    s_add_u32 m0, s50, 81920
    s_nop 0
    buffer_load_dwordx4 v9, s[32:35], s51 offen lds
    s_waitcnt lgkmcnt(5)
    s_setprio 1
    v_mfma_f32_32x32x16_bf16 v[52:67], v[204:207], v[44:47], v[52:67]
    v_mfma_f32_32x32x16_bf16 v[68:83], v[204:207], v[48:51], v[68:83]
    s_setprio 0
    ds_read_b128 v[212:215], v16
    ds_read_b64_tr_b16 v[28:29], v19 offset:18432
    ds_read_b64_tr_b16 v[30:31], v19 offset:18944
    ds_read_b64_tr_b16 v[32:33], v19 offset:26624
    ds_read_b64_tr_b16 v[34:35], v19 offset:27136
    s_add_u32 s51, s69, 2048
    s_add_u32 m0, s50, 90112
    s_nop 0
    buffer_load_dwordx4 v9, s[32:35], s51 offen lds
    s_waitcnt lgkmcnt(5)
    s_setprio 1
    v_mfma_f32_32x32x16_bf16 v[52:67], v[208:211], v[20:23], v[52:67]
    v_mfma_f32_32x32x16_bf16 v[68:83], v[208:211], v[24:27], v[68:83]
    s_setprio 0
    ds_read_b128 v[216:219], v17
    ds_read_b64_tr_b16 v[36:37], v19 offset:20480
    ds_read_b64_tr_b16 v[38:39], v19 offset:20992
    ds_read_b64_tr_b16 v[40:41], v19 offset:28672
    ds_read_b64_tr_b16 v[42:43], v19 offset:29184
    s_add_u32 s59, s58, 0
    s_and_b32 s59, s59, 7
    s_lshl_b32 s68, s59, 7
    s_mul_i32 s69, s59, 196608
    s_add_u32 m0, s50, 98304
    s_nop 0
    buffer_load_dwordx4 v9, s[32:35], s69 offen lds
    s_waitcnt lgkmcnt(5)
    v_mfma_f32_32x32x16_bf16 v[52:67], v[212:215], v[28:31], v[52:67]
    ds_read_b128 v[220:223], v18
    ds_read_b64_tr_b16 v[44:45], v19 offset:22528
    ds_read_b64_tr_b16 v[46:47], v19 offset:23040
    ds_read_b64_tr_b16 v[48:49], v19 offset:30720
    ds_read_b64_tr_b16 v[50:51], v19 offset:31232
    s_add_u32 s59, s58, 1
    s_and_b32 s59, s59, 7
    s_lshl_b32 s68, s59, 7
    s_mul_i32 s69, s59, 196608
    s_add_u32 m0, s50, 106496
    s_nop 0
    buffer_load_dwordx4 v9, s[32:35], s69 offen lds
    s_waitcnt vmcnt(6) lgkmcnt(5)
    v_mfma_f32_32x32x16_bf16 v[68:83], v[212:215], v[32:35], v[68:83]
    s_barrier
    s_setprio 1
    v_mfma_f32_32x32x16_bf16 v[52:67], v[216:219], v[36:39], v[52:67]
    v_mfma_f32_32x32x16_bf16 v[68:83], v[216:219], v[40:43], v[68:83]
    s_setprio 0
    v_add_u32 v15, 32768, v10
    v_add_u32 v16, 32768, v11
    v_add_u32 v17, 32768, v12
    v_add_u32 v18, 32768, v13
    v_add_u32 v19, 32768, v14
    ds_read_b128 v[224:227], v15
    ds_read_b64_tr_b16 v[20:21], v19 offset:16384
    ds_read_b64_tr_b16 v[22:23], v19 offset:16896
    ds_read_b64_tr_b16 v[24:25], v19 offset:24576
    ds_read_b64_tr_b16 v[26:27], v19 offset:25088
    s_add_u32 s59, s58, 2
    s_and_b32 s59, s59, 7
    s_lshl_b32 s68, s59, 7
    s_mul_i32 s69, s59, 196608
    s_add_u32 m0, s50, 114688
    s_nop 0
    buffer_load_dwordx4 v9, s[32:35], s69 offen lds
    s_waitcnt lgkmcnt(5)
    s_setprio 1
    v_mfma_f32_32x32x16_bf16 v[52:67], v[220:223], v[44:47], v[52:67]
    v_mfma_f32_32x32x16_bf16 v[68:83], v[220:223], v[48:51], v[68:83]
    s_setprio 0
    ds_read_b128 v[228:231], v16
    ds_read_b64_tr_b16 v[28:29], v19 offset:18432
    ds_read_b64_tr_b16 v[30:31], v19 offset:18944
    ds_read_b64_tr_b16 v[32:33], v19 offset:26624
    ds_read_b64_tr_b16 v[34:35], v19 offset:27136
    s_add_u32 s59, s58, 3
    s_and_b32 s59, s59, 7
    s_lshl_b32 s68, s59, 7
    s_mul_i32 s69, s59, 196608
    s_add_u32 m0, s50, 122880
    s_nop 0
    buffer_load_dwordx4 v9, s[32:35], s69 offen lds
    s_waitcnt lgkmcnt(5)
    s_setprio 1
    v_mfma_f32_32x32x16_bf16 v[52:67], v[224:227], v[20:23], v[52:67]
    v_mfma_f32_32x32x16_bf16 v[68:83], v[224:227], v[24:27], v[68:83]
    s_setprio 0
    ds_read_b128 v[232:235], v17
    ds_read_b64_tr_b16 v[36:37], v19 offset:20480
    ds_read_b64_tr_b16 v[38:39], v19 offset:20992
    ds_read_b64_tr_b16 v[40:41], v19 offset:28672
    ds_read_b64_tr_b16 v[42:43], v19 offset:29184
    s_add_u32 s59, s58, 4
    s_and_b32 s59, s59, 7
    s_lshl_b32 s68, s59, 7
    s_mul_i32 s69, s59, 196608
    s_add_u32 m0, s50, 131072
    s_nop 0
    buffer_load_dwordx4 v9, s[32:35], s69 offen lds
    s_waitcnt lgkmcnt(5)
    v_mfma_f32_32x32x16_bf16 v[52:67], v[228:231], v[28:31], v[52:67]
    ds_read_b128 v[236:239], v18
    ds_read_b64_tr_b16 v[44:45], v19 offset:22528
    ds_read_b64_tr_b16 v[46:47], v19 offset:23040
    ds_read_b64_tr_b16 v[48:49], v19 offset:30720
    ds_read_b64_tr_b16 v[50:51], v19 offset:31232
    s_add_u32 s59, s58, 5
    s_and_b32 s59, s59, 7
    s_lshl_b32 s68, s59, 7
    s_mul_i32 s69, s59, 196608
    s_add_u32 m0, s50, 139264
    s_nop 0
    buffer_load_dwordx4 v9, s[32:35], s69 offen lds
    s_waitcnt vmcnt(6) lgkmcnt(5)
    v_mfma_f32_32x32x16_bf16 v[68:83], v[228:231], v[32:35], v[68:83]
    s_barrier
    s_setprio 1
    v_mfma_f32_32x32x16_bf16 v[52:67], v[232:235], v[36:39], v[52:67]
    v_mfma_f32_32x32x16_bf16 v[68:83], v[232:235], v[40:43], v[68:83]
    s_setprio 0
    v_add_u32 v15, 65536, v10
    v_add_u32 v16, 65536, v11
    v_add_u32 v17, 65536, v12
    v_add_u32 v18, 65536, v13
    v_add_u32 v19, 65536, v14
    ds_read_b128 v[240:243], v15
    ds_read_b64_tr_b16 v[20:21], v19 offset:16384
    ds_read_b64_tr_b16 v[22:23], v19 offset:16896
    ds_read_b64_tr_b16 v[24:25], v19 offset:24576
    ds_read_b64_tr_b16 v[26:27], v19 offset:25088
    s_add_u32 s59, s58, 6
    s_and_b32 s59, s59, 7
    s_lshl_b32 s68, s59, 7
    s_mul_i32 s69, s59, 196608
    s_add_u32 m0, s50, 147456
    s_nop 0
    buffer_load_dwordx4 v9, s[32:35], s69 offen lds
    s_waitcnt lgkmcnt(5)
    s_setprio 1
    v_mfma_f32_32x32x16_bf16 v[52:67], v[236:239], v[44:47], v[52:67]
    v_mfma_f32_32x32x16_bf16 v[68:83], v[236:239], v[48:51], v[68:83]
    s_setprio 0
    ds_read_b128 v[244:247], v16
    ds_read_b64_tr_b16 v[28:29], v19 offset:18432
    ds_read_b64_tr_b16 v[30:31], v19 offset:18944
    ds_read_b64_tr_b16 v[32:33], v19 offset:26624
    ds_read_b64_tr_b16 v[34:35], v19 offset:27136
    s_add_u32 s59, s58, 7
    s_and_b32 s59, s59, 7
    s_lshl_b32 s68, s59, 7
    s_mul_i32 s69, s59, 196608
    s_add_u32 m0, s50, 155648
    s_nop 0
    buffer_load_dwordx4 v9, s[32:35], s69 offen lds
    s_waitcnt lgkmcnt(5)
    s_setprio 1
    v_mfma_f32_32x32x16_bf16 v[52:67], v[240:243], v[20:23], v[52:67]
    v_mfma_f32_32x32x16_bf16 v[68:83], v[240:243], v[24:27], v[68:83]
    s_setprio 0
    ds_read_b128 v[248:251], v17
    ds_read_b64_tr_b16 v[36:37], v19 offset:20480
    ds_read_b64_tr_b16 v[38:39], v19 offset:20992
    ds_read_b64_tr_b16 v[40:41], v19 offset:28672
    ds_read_b64_tr_b16 v[42:43], v19 offset:29184
    s_mov_b32 s51, 0
    s_add_u32 m0, s50, 0
    s_nop 0
    buffer_load_dwordx4 v2, s[60:63], s51 offen lds
    s_waitcnt lgkmcnt(5)
    v_mfma_f32_32x32x16_bf16 v[52:67], v[244:247], v[28:31], v[52:67]
    ds_read_b128 v[252:255], v18
    ds_read_b64_tr_b16 v[44:45], v19 offset:22528
    ds_read_b64_tr_b16 v[46:47], v19 offset:23040
    ds_read_b64_tr_b16 v[48:49], v19 offset:30720
    ds_read_b64_tr_b16 v[50:51], v19 offset:31232
    s_mov_b32 s51, 65536
    s_add_u32 m0, s50, 8192
    s_nop 0
    buffer_load_dwordx4 v2, s[60:63], s51 offen lds
    s_waitcnt vmcnt(6) lgkmcnt(5)
    v_mfma_f32_32x32x16_bf16 v[68:83], v[244:247], v[32:35], v[68:83]
    s_barrier
    s_setprio 1
    v_mfma_f32_32x32x16_bf16 v[52:67], v[248:251], v[36:39], v[52:67]
    v_mfma_f32_32x32x16_bf16 v[68:83], v[248:251], v[40:43], v[68:83]
    s_setprio 0
    v_add_u32 v19, 98304, v14
    ds_read_b64_tr_b16 v[20:21], v19 offset:0
    ds_read_b64_tr_b16 v[22:23], v19 offset:512
    ds_read_b64_tr_b16 v[24:25], v19 offset:2048
    ds_read_b64_tr_b16 v[26:27], v19 offset:2560
    s_mov_b32 s51, 131072
    s_add_u32 m0, s50, 16384
    s_nop 0
    buffer_load_dwordx4 v2, s[60:63], s51 offen lds
    s_waitcnt lgkmcnt(4)
    s_setprio 1
    v_mfma_f32_32x32x16_bf16 v[52:67], v[252:255], v[44:47], v[52:67]
    v_mfma_f32_32x32x16_bf16 v[68:83], v[252:255], v[48:51], v[68:83]
    s_setprio 0
    ds_read_b64_tr_b16 v[28:29], v19 offset:4096
    ds_read_b64_tr_b16 v[30:31], v19 offset:4608
    ds_read_b64_tr_b16 v[32:33], v19 offset:6144
    ds_read_b64_tr_b16 v[34:35], v19 offset:6656
    s_mov_b32 s51, 196608
    s_add_u32 m0, s50, 24576
    s_nop 0
    buffer_load_dwordx4 v2, s[60:63], s51 offen lds
    v_and_b32 v5, 7, v1
    v_lshlrev_b32 v5, 2, v5
    buffer_load_dword v127, v5, s[40:43], 0 offen sc1
    v_add_u32 v15, 131072, v14
    s_waitcnt lgkmcnt(6)
    v_mfma_f32_32x32x16_bf16 v[84:99], v[20:23], v[128:131], v[84:99]
    ds_read_b64_tr_b16 v[36:37], v19 offset:8192
    ds_read_b64_tr_b16 v[38:39], v19 offset:8704
    v_mov_b32 v3, 0
    v_mov_b32 v4, 0x3f803f80
    v_cvt_pk_bf16_f32 v108, v68, v69
    v_cvt_pk_bf16_f32 v109, v70, v71
    v_cvt_pk_bf16_f32 v110, v72, v73
    v_cvt_pk_bf16_f32 v111, v74, v75
    v_cvt_pk_bf16_f32 v112, v76, v77
    v_cvt_pk_bf16_f32 v113, v78, v79
    v_cvt_pk_bf16_f32 v114, v80, v81
    v_cvt_pk_bf16_f32 v115, v82, v83
    v_mul_f32 v116, 0x3fb8aa3b, v52
    s_waitcnt lgkmcnt(6)
    v_mfma_f32_32x32x16_bf16 v[84:99], v[24:27], v[132:135], v[84:99]
    ds_read_b64_tr_b16 v[40:41], v19 offset:10240
    ds_read_b64_tr_b16 v[42:43], v19 offset:10752
    v_mul_f32 v117, 0x3fb8aa3b, v53
    v_mul_f32 v118, 0x3fb8aa3b, v54
    v_mul_f32 v119, 0x3fb8aa3b, v55
    v_exp_f32 v116, v116 clamp
    v_exp_f32 v117, v117 clamp
    v_exp_f32 v118, v118 clamp
    v_exp_f32 v119, v119 clamp
    v_max_f32 v52, 0x358637bd, v52
    v_max_f32 v53, 0x358637bd, v53
    v_max_f32 v54, 0x358637bd, v54
    v_max_f32 v55, 0x358637bd, v55
    s_waitcnt lgkmcnt(6)
    v_mfma_f32_32x32x16_bf16 v[84:99], v[28:31], v[136:139], v[84:99]
    ds_read_b64_tr_b16 v[44:45], v19 offset:12288
    ds_read_b64_tr_b16 v[46:47], v19 offset:12800
    v_add_f32 v52, v52, v116
    v_add_f32 v53, v53, v117
    v_add_f32 v54, v54, v118
    v_add_f32 v55, v55, v119
    v_cvt_pk_bf16_f32 v100, v52, v53
    v_cvt_pk_bf16_f32 v101, v54, v55
    v_mul_f32 v116, 0x3fb8aa3b, v56
    v_mul_f32 v117, 0x3fb8aa3b, v57
    v_mul_f32 v118, 0x3fb8aa3b, v58
    v_mul_f32 v119, 0x3fb8aa3b, v59
    v_exp_f32 v116, v116 clamp
    s_waitcnt lgkmcnt(6)
    v_mfma_f32_32x32x16_bf16 v[84:99], v[32:35], v[140:143], v[84:99]
    ds_read_b64_tr_b16 v[48:49], v19 offset:14336
    ds_read_b64_tr_b16 v[50:51], v19 offset:14848
    v_exp_f32 v117, v117 clamp
    v_exp_f32 v118, v118 clamp
    v_exp_f32 v119, v119 clamp
    v_max_f32 v56, 0x358637bd, v56
    v_max_f32 v57, 0x358637bd, v57
    v_max_f32 v58, 0x358637bd, v58
    v_max_f32 v59, 0x358637bd, v59
    v_add_f32 v56, v56, v116
    v_add_f32 v57, v57, v117
    v_add_f32 v58, v58, v118
    v_add_f32 v59, v59, v119
    s_waitcnt lgkmcnt(6)
    v_mfma_f32_32x32x16_bf16 v[84:99], v[36:39], v[144:147], v[84:99]
    ds_read_b64_tr_b16 v[20:21], v19 offset:16384
    ds_read_b64_tr_b16 v[22:23], v19 offset:16896
    v_cvt_pk_bf16_f32 v102, v56, v57
    v_cvt_pk_bf16_f32 v103, v58, v59
    v_mul_f32 v116, 0x3fb8aa3b, v60
    v_mul_f32 v117, 0x3fb8aa3b, v61
    v_mul_f32 v118, 0x3fb8aa3b, v62
    v_mul_f32 v119, 0x3fb8aa3b, v63
    v_exp_f32 v116, v116 clamp
    v_exp_f32 v117, v117 clamp
    v_exp_f32 v118, v118 clamp
    v_exp_f32 v119, v119 clamp
    v_max_f32 v60, 0x358637bd, v60
    s_waitcnt lgkmcnt(6)
    v_mfma_f32_32x32x16_bf16 v[84:99], v[40:43], v[148:151], v[84:99]
    ds_read_b64_tr_b16 v[24:25], v19 offset:18432
    ds_read_b64_tr_b16 v[26:27], v19 offset:18944
    v_max_f32 v61, 0x358637bd, v61
    v_max_f32 v62, 0x358637bd, v62
    v_max_f32 v63, 0x358637bd, v63
    v_add_f32 v60, v60, v116
    v_add_f32 v61, v61, v117
    v_add_f32 v62, v62, v118
    v_add_f32 v63, v63, v119
    v_cvt_pk_bf16_f32 v104, v60, v61
    v_cvt_pk_bf16_f32 v105, v62, v63
    v_mul_f32 v116, 0x3fb8aa3b, v64
    v_mul_f32 v117, 0x3fb8aa3b, v65
    s_waitcnt lgkmcnt(6)
    v_mfma_f32_32x32x16_bf16 v[84:99], v[44:47], v[152:155], v[84:99]
    ds_read_b64_tr_b16 v[28:29], v19 offset:20480
    ds_read_b64_tr_b16 v[30:31], v19 offset:20992
    v_mul_f32 v118, 0x3fb8aa3b, v66
    v_mul_f32 v119, 0x3fb8aa3b, v67
    v_exp_f32 v116, v116 clamp
    v_exp_f32 v117, v117 clamp
    v_exp_f32 v118, v118 clamp
    v_exp_f32 v119, v119 clamp
    v_max_f32 v64, 0x358637bd, v64
    v_max_f32 v65, 0x358637bd, v65
    v_max_f32 v66, 0x358637bd, v66
    v_max_f32 v67, 0x358637bd, v67
    v_add_f32 v64, v64, v116
    s_waitcnt lgkmcnt(6)
    v_mfma_f32_32x32x16_bf16 v[84:99], v[48:51], v[156:159], v[84:99]
    ds_read_b64_tr_b16 v[32:33], v19 offset:22528
    ds_read_b64_tr_b16 v[34:35], v19 offset:23040
    v_add_f32 v65, v65, v117
    v_add_f32 v66, v66, v118
    v_add_f32 v67, v67, v119
    v_cvt_pk_bf16_f32 v106, v64, v65
    v_cvt_pk_bf16_f32 v107, v66, v67
    v_mfma_f32_32x32x16_bf16 v[52:67], v[100:103], v[108:111], 0
    s_nop 0
    v_mfma_f32_32x32x16_bf16 v[52:67], v[104:107], v[112:115], v[52:67]
    s_waitcnt lgkmcnt(6)
    v_mfma_f32_32x32x16_bf16 v[84:99], v[20:23], v[160:163], v[84:99]
    ds_read_b64_tr_b16 v[36:37], v19 offset:24576
    ds_read_b64_tr_b16 v[38:39], v19 offset:25088
    v_dot2c_f32_bf16 v3, v100, v4
    v_dot2c_f32_bf16 v3, v101, v4
    v_dot2c_f32_bf16 v3, v102, v4
    v_dot2c_f32_bf16 v3, v103, v4
    s_waitcnt lgkmcnt(6)
    v_mfma_f32_32x32x16_bf16 v[84:99], v[24:27], v[164:167], v[84:99]
    ds_read_b64_tr_b16 v[40:41], v19 offset:26624
    ds_read_b64_tr_b16 v[42:43], v19 offset:27136
    v_dot2c_f32_bf16 v3, v104, v4
    v_dot2c_f32_bf16 v3, v105, v4
    v_dot2c_f32_bf16 v3, v106, v4
    v_dot2c_f32_bf16 v3, v107, v4
    s_waitcnt lgkmcnt(6)
    v_mfma_f32_32x32x16_bf16 v[84:99], v[28:31], v[168:171], v[84:99]
    ds_read_b64_tr_b16 v[44:45], v19 offset:28672
    ds_read_b64_tr_b16 v[46:47], v19 offset:29184
    ds_write_b32 v121, v3
    v_cndmask_b32 v108, v52, v60, s[52:53]
    v_cndmask_b32 v109, v53, v61, s[52:53]
    v_cndmask_b32 v110, v54, v62, s[52:53]
    v_cndmask_b32 v111, v55, v63, s[52:53]
    v_cndmask_b32 v112, v56, v64, s[52:53]
    v_cndmask_b32 v113, v57, v65, s[52:53]
    v_cndmask_b32 v114, v58, v66, s[52:53]
    v_cndmask_b32 v115, v59, v67, s[52:53]
    ds_write_b128 v120, v[108:111]
    ds_write_b128 v120, v[112:115] offset:16
    s_waitcnt lgkmcnt(9)
    v_mfma_f32_32x32x16_bf16 v[84:99], v[32:35], v[172:175], v[84:99]
    s_waitcnt vmcnt(0) lgkmcnt(0)
    s_barrier
    ds_read_b64_tr_b16 v[48:49], v19 offset:30720
    ds_read_b64_tr_b16 v[50:51], v19 offset:31232
    v_cmp_ne_u32 vcc, 1, v127
    s_nop 4
    s_cbranch_vccz Lgo_23
Lg_22:
    buffer_load_dword v127, v5, s[40:43], 0 offen sc1
    s_waitcnt vmcnt(0)
    v_cmp_ne_u32 vcc, 1, v127
    s_nop 4
    s_cbranch_vccnz Lg_22
Lgo_23:
    ds_read_b32 v100, v122 offset:0
    ds_read_b32 v101, v122 offset:2048
    ds_read_b32 v102, v122 offset:4096
    ds_read_b32 v103, v122 offset:6144
    ds_read_b32 v104, v122 offset:256
    ds_read_b32 v105, v122 offset:2304
    ds_read_b32 v106, v122 offset:4352
    ds_read_b32 v107, v122 offset:6400
    v_mfma_f32_32x32x16_bf16 v[84:99], v[36:39], v[176:179], v[84:99]
    ds_read_b64_tr_b16 v[20:21], v15 offset:0
    ds_read_b64_tr_b16 v[22:23], v15 offset:512
    ds_read_b32 v108, v123 offset:0
    ds_read_b32 v109, v123 offset:128
    ds_read_b32 v110, v123 offset:256
    s_waitcnt lgkmcnt(14)
    ds_read_b32 v111, v123 offset:384
    s_waitcnt lgkmcnt(14)
    ds_read_b32 v112, v123 offset:512
    s_waitcnt lgkmcnt(14)
    ds_read_b32 v113, v123 offset:640
    s_waitcnt lgkmcnt(14)
    ds_read_b32 v114, v123 offset:768
    s_waitcnt lgkmcnt(14)
    ds_read_b32 v115, v123 offset:896
    s_waitcnt lgkmcnt(10)
    v_add_f32 v100, v100, v101
    v_add_f32 v102, v102, v103
    v_add_f32 v100, v100, v102
    v_add_f32 v104, v104, v105
    v_add_f32 v106, v106, v107
    v_add_f32 v104, v104, v106
    buffer_atomic_add_f32 v100, v125, s[36:39], 0 offen offset:0
    buffer_atomic_add_f32 v104, v125, s[36:39], 0 offen offset:256
    v_mfma_f32_32x32x16_bf16 v[84:99], v[40:43], v[180:183], v[84:99]
    ds_read_b64_tr_b16 v[24:25], v15 offset:2048
    ds_read_b64_tr_b16 v[26:27], v15 offset:2560
    s_waitcnt lgkmcnt(2)
    v_add_f32 v108, v108, v109
    v_add_f32 v110, v110, v111
    v_add_f32 v112, v112, v113
    v_add_f32 v114, v114, v115
    v_add_f32 v108, v108, v110
    v_add_f32 v112, v112, v114
    v_add_f32 v108, v108, v112
    s_and_b32 s47, s44, 3
    s_cmp_eq_u32 s47, 0
    s_cbranch_scc0 Lz_24
    s_mov_b64 s[56:57], exec
    s_mov_b32 exec_lo, -1
    s_mov_b32 exec_hi, 0
    buffer_atomic_add_f32 v108, v126, s[36:39], 0 offen
    s_mov_b64 exec, s[56:57]
Lz_24:
    v_mfma_f32_32x32x16_bf16 v[84:99], v[44:47], v[184:187], v[84:99]
    ds_read_b64_tr_b16 v[28:29], v15 offset:4096
    ds_read_b64_tr_b16 v[30:31], v15 offset:4608
    s_mov_b32 s51, 262144
    s_add_u32 m0, s50, 65536
    s_nop 0
    buffer_load_dwordx4 v2, s[60:63], s51 offen lds
    v_mfma_f32_32x32x16_bf16 v[84:99], v[48:51], v[188:191], v[84:99]
    ds_read_b64_tr_b16 v[32:33], v15 offset:6144
    ds_read_b64_tr_b16 v[34:35], v15 offset:6656
    s_mov_b32 s51, 327680
    s_add_u32 m0, s50, 73728
    s_nop 0
    buffer_load_dwordx4 v2, s[60:63], s51 offen lds
    v_mfma_f32_32x32x16_bf16 v[84:99], v[20:23], v[192:195], v[84:99]
    ds_read_b64_tr_b16 v[36:37], v15 offset:8192
    ds_read_b64_tr_b16 v[38:39], v15 offset:8704
    s_mov_b32 s51, 393216
    s_add_u32 m0, s50, 81920
    s_nop 0
    buffer_load_dwordx4 v2, s[60:63], s51 offen lds
    s_waitcnt lgkmcnt(6)
    v_mfma_f32_32x32x16_bf16 v[84:99], v[24:27], v[196:199], v[84:99]
    ds_read_b64_tr_b16 v[40:41], v15 offset:10240
    ds_read_b64_tr_b16 v[42:43], v15 offset:10752
    s_mov_b32 s51, 458752
    s_add_u32 m0, s50, 90112
    s_nop 0
    buffer_load_dwordx4 v2, s[60:63], s51 offen lds
    s_waitcnt lgkmcnt(6)
    v_mfma_f32_32x32x16_bf16 v[84:99], v[28:31], v[200:203], v[84:99]
    ds_read_b64_tr_b16 v[44:45], v15 offset:12288
    ds_read_b64_tr_b16 v[46:47], v15 offset:12800
    s_waitcnt lgkmcnt(6)
    v_mfma_f32_32x32x16_bf16 v[84:99], v[32:35], v[204:207], v[84:99]
    ds_read_b64_tr_b16 v[48:49], v15 offset:14336
    ds_read_b64_tr_b16 v[50:51], v15 offset:14848
    s_waitcnt lgkmcnt(6)
    v_mfma_f32_32x32x16_bf16 v[84:99], v[36:39], v[208:211], v[84:99]
    ds_read_b64_tr_b16 v[20:21], v15 offset:16384
    ds_read_b64_tr_b16 v[22:23], v15 offset:16896
    s_waitcnt lgkmcnt(6)
    v_mfma_f32_32x32x16_bf16 v[84:99], v[40:43], v[212:215], v[84:99]
    ds_read_b64_tr_b16 v[24:25], v15 offset:18432
    ds_read_b64_tr_b16 v[26:27], v15 offset:18944
    s_waitcnt lgkmcnt(6)
    v_mfma_f32_32x32x16_bf16 v[84:99], v[44:47], v[216:219], v[84:99]
    ds_read_b64_tr_b16 v[28:29], v15 offset:20480
    ds_read_b64_tr_b16 v[30:31], v15 offset:20992
    s_waitcnt lgkmcnt(6)
    v_mfma_f32_32x32x16_bf16 v[84:99], v[48:51], v[220:223], v[84:99]
    ds_read_b64_tr_b16 v[32:33], v15 offset:22528
    ds_read_b64_tr_b16 v[34:35], v15 offset:23040
    s_waitcnt lgkmcnt(6)
    v_mfma_f32_32x32x16_bf16 v[84:99], v[20:23], v[224:227], v[84:99]
    ds_read_b64_tr_b16 v[36:37], v15 offset:24576
    ds_read_b64_tr_b16 v[38:39], v15 offset:25088
    s_waitcnt lgkmcnt(6)
    v_mfma_f32_32x32x16_bf16 v[84:99], v[24:27], v[228:231], v[84:99]
    ds_read_b64_tr_b16 v[40:41], v15 offset:26624
    ds_read_b64_tr_b16 v[42:43], v15 offset:27136
    s_waitcnt lgkmcnt(6)
    v_mfma_f32_32x32x16_bf16 v[84:99], v[28:31], v[232:235], v[84:99]
    ds_read_b64_tr_b16 v[44:45], v15 offset:28672
    ds_read_b64_tr_b16 v[46:47], v15 offset:29184
    s_waitcnt lgkmcnt(6)
    v_mfma_f32_32x32x16_bf16 v[84:99], v[32:35], v[236:239], v[84:99]
    ds_read_b64_tr_b16 v[48:49], v15 offset:30720
    ds_read_b64_tr_b16 v[50:51], v15 offset:31232
    s_waitcnt lgkmcnt(6)
    v_mfma_f32_32x32x16_bf16 v[84:99], v[36:39], v[240:243], v[84:99]
    s_waitcnt lgkmcnt(4)
    v_mfma_f32_32x32x16_bf16 v[84:99], v[40:43], v[244:247], v[84:99]
    s_waitcnt lgkmcnt(2)
    v_mfma_f32_32x32x16_bf16 v[84:99], v[44:47], v[248:251], v[84:99]
    s_waitcnt lgkmcnt(0)
    v_mfma_f32_32x32x16_bf16 v[84:99], v[48:51], v[252:255], v[84:99]
    s_waitcnt vmcnt(0)
    s_barrier
    s_cmp_eq_u32 s44, 6
    s_cbranch_scc0 Lkf_25
    s_lshl_b32 s47, s4, 7
    s_add_u32 s47, s47, 65536
    v_lshlrev_b32 v3, 10, v1
    v_add_u32 v3, s47, v3
    v_mov_b32 v4, 1
    s_mov_b64 s[56:57], exec
    s_mov_b64 exec, 0xff
    buffer_atomic_add v4, v3, s[36:39], 0 offen
    s_mov_b64 exec, s[56:57]
Lkf_25:
    s_nop 7
    v_mul_f32 v116, 0x3fb8aa3b, v84
    v_mul_f32 v117, 0x3fb8aa3b, v85
    v_mul_f32 v118, 0x3fb8aa3b, v86
    v_mul_f32 v119, 0x3fb8aa3b, v87
    v_exp_f32 v116, v116 clamp
    v_exp_f32 v117, v117 clamp
    v_exp_f32 v118, v118 clamp
    v_exp_f32 v119, v119 clamp
    v_max_f32 v84, 0x358637bd, v84
    v_max_f32 v85, 0x358637bd, v85
    v_max_f32 v86, 0x358637bd, v86
    v_max_f32 v87, 0x358637bd, v87
    v_add_f32 v84, v84, v116
    v_add_f32 v85, v85, v117
    v_add_f32 v86, v86, v118
    v_add_f32 v87, v87, v119
    v_cvt_pk_bf16_f32 v100, v84, v85
    v_cvt_pk_bf16_f32 v101, v86, v87
    v_mul_f32 v116, 0x3fb8aa3b, v88
    v_mul_f32 v117, 0x3fb8aa3b, v89
    v_mul_f32 v118, 0x3fb8aa3b, v90
    v_mul_f32 v119, 0x3fb8aa3b, v91
    v_exp_f32 v116, v116 clamp
    v_exp_f32 v117, v117 clamp
    v_exp_f32 v118, v118 clamp
    v_exp_f32 v119, v119 clamp
    v_max_f32 v88, 0x358637bd, v88
    v_max_f32 v89, 0x358637bd, v89
    v_max_f32 v90, 0x358637bd, v90
    v_max_f32 v91, 0x358637bd, v91
    v_add_f32 v88, v88, v116
    v_add_f32 v89, v89, v117
    v_add_f32 v90, v90, v118
    v_add_f32 v91, v91, v119
    v_cvt_pk_bf16_f32 v102, v88, v89
    v_cvt_pk_bf16_f32 v103, v90, v91
    buffer_store_dwordx4 v[100:103], v124, s[36:39], 0 offen sc1
    v_mul_f32 v116, 0x3fb8aa3b, v92
    v_mul_f32 v117, 0x3fb8aa3b, v93
    v_mul_f32 v118, 0x3fb8aa3b, v94
    v_mul_f32 v119, 0x3fb8aa3b, v95
    v_exp_f32 v116, v116 clamp
    v_exp_f32 v117, v117 clamp
    v_exp_f32 v118, v118 clamp
    v_exp_f32 v119, v119 clamp
    v_max_f32 v92, 0x358637bd, v92
    v_max_f32 v93, 0x358637bd, v93
    v_max_f32 v94, 0x358637bd, v94
    v_max_f32 v95, 0x358637bd, v95
    v_add_f32 v92, v92, v116
    v_add_f32 v93, v93, v117
    v_add_f32 v94, v94, v118
    v_add_f32 v95, v95, v119
    v_cvt_pk_bf16_f32 v104, v92, v93
    v_cvt_pk_bf16_f32 v105, v94, v95
    v_mul_f32 v116, 0x3fb8aa3b, v96
    v_mul_f32 v117, 0x3fb8aa3b, v97
    v_mul_f32 v118, 0x3fb8aa3b, v98
    v_mul_f32 v119, 0x3fb8aa3b, v99
    v_exp_f32 v116, v116 clamp
    v_exp_f32 v117, v117 clamp
    v_exp_f32 v118, v118 clamp
    v_exp_f32 v119, v119 clamp
    v_max_f32 v96, 0x358637bd, v96
    v_max_f32 v97, 0x358637bd, v97
    v_max_f32 v98, 0x358637bd, v98
    v_max_f32 v99, 0x358637bd, v99
    v_add_f32 v96, v96, v116
    v_add_f32 v97, v97, v117
    v_add_f32 v98, v98, v118
    v_add_f32 v99, v99, v119
    v_cvt_pk_bf16_f32 v106, v96, v97
    v_cvt_pk_bf16_f32 v107, v98, v99
    s_mov_b32 s51, 65536
    buffer_store_dwordx4 v[104:107], v124, s[36:39], s51 offen sc1
    v_lshlrev_b32 v3, 4, v1
    s_lshl_b32 s48, s44, 12
    v_add_u32 v11, s48, v3
    s_and_b32 s48, s44, 1
    s_lshl_b32 s48, s48, 10
    s_add_u32 s48, s48, 32768
    v_add_u32 v12, s48, v3
    s_lshl_b32 s47, s46, 10
    s_lshl_b32 s48, s3, 2
    s_add_u32 s47, s47, s48
    s_add_u32 s47, s47, s45
    s_lshl_b32 s47, s47, 10
    s_add_u32 s47, s47, 1048576
    v_add_u32 v13, s47, v3
    v_lshrrev_b32 v4, 5, v1
    v_lshlrev_b32 v4, 9, v4
    v_bfe_u32 v5, v1, 1, 4
    v_lshlrev_b32 v5, 4, v5
    v_and_b32 v6, 1, v1
    v_lshlrev_b32 v6, 3, v6
    v_add3_u32 v14, v4, v5, v6
    s_lshl_b32 s48, s44, 12
    s_add_u32 s48, s48, 98304
    v_add_u32 v14, s48, v14
    s_and_b32 s48, s44, 1
    s_lshl_b32 s48, s48, 14
    s_add_u32 s48, s48, 98560
    v_lshrrev_b32 v5, 2, v1
    v_lshlrev_b32 v5, 10, v5
    v_bfe_u32 v6, v1, 1, 1
    v_lshlrev_b32 v6, 9, v6
    v_add3_u32 v15, v5, v6, s48
    v_and_b32 v6, 1, v1
    v_lshlrev_b32 v6, 3, v6
    v_add_u32 v15, v15, v6
    v_lshlrev_b32 v8, 4, v1
    s_lshl_b32 s47, s46, 14
    s_add_u32 s47, s47, 98304
    v_add_u32 v8, s47, v8
    v_lshrrev_b32 v4, 5, v1
    v_bfe_u32 v3, v1, 2, 2
    v_lshlrev_b32 v5, 2, v4
    v_add_u32 v5, v5, v3
    v_lshlrev_b32 v9, 7, v5
    v_lshrrev_b32 v3, 1, v3
    v_lshlrev_b32 v6, 6, v3
    v_bfe_u32 v5, v1, 4, 1
    v_lshlrev_b32 v5, 5, v5
    v_add_u32 v9, v9, v5
    v_and_b32 v5, 3, v1
    v_lshlrev_b32 v5, 3, v5
    v_add_u32 v9, v9, v5
    s_lshl_b32 s47, s46, 16
    v_add_u32 v9, s47, v9
    v_xor_b32 v10, 64, v6
    v_add_u32 v10, v10, v9
    v_add_u32 v9, v9, v6
    s_lshl_b32 s47, s44, 12
    s_add_u32 s47, s47, 131072
    v_lshlrev_b32 v192, 4, v1
    v_add_u32 v192, s47, v192
    s_xor_b32 s47, s44, 4
    s_lshl_b32 s47, s47, 12
    s_add_u32 s47, s47, 131072
    v_lshlrev_b32 v193, 4, v1
    v_add_u32 v193, s47, v193
    v_and_b32 v194, 31, v1
    s_lshl_b32 s47, s45, 5
    v_add_u32 v194, s47, v194
    v_mul_u32_u24 v194, 144, v194
    v_lshrrev_b32 v6, 5, v1
    v_lshlrev_b32 v6, 3, v6
    s_lshl_b32 s47, s46, 6
    v_add3_u32 v194, v194, v6, s47
    v_lshrrev_b32 v196, 3, v1
    s_lshl_b32 s47, s44, 4
    v_add_u32 v196, s47, v196
    v_and_b32 v6, 7, v1
    v_lshlrev_b32 v6, 4, v6
    v_mul_u32_u24 v195, 144, v196
    v_add_u32 v195, v195, v6
    s_lshl_b32 s47, s3, 7
    v_add_u32 v196, s47, v196
    v_lshlrev_b32 v196, 11, v196
    s_lshl_b32 s47, s4, 7
    s_add_u32 s47, s47, 1024
    v_add3_u32 v196, v196, v6, s47
    v_mov_b32 v16, 0
    v_mov_b32 v32, 0
    v_mov_b32 v17, 0
    v_mov_b32 v33, 0
    v_mov_b32 v18, 0
    v_mov_b32 v34, 0
    v_mov_b32 v19, 0
    v_mov_b32 v35, 0
    v_mov_b32 v20, 0
    v_mov_b32 v36, 0
    v_mov_b32 v21, 0
    v_mov_b32 v37, 0
    v_mov_b32 v22, 0
    v_mov_b32 v38, 0
    v_mov_b32 v23, 0
    v_mov_b32 v39, 0
    v_mov_b32 v24, 0
    v_mov_b32 v40, 0
    v_mov_b32 v25, 0
    v_mov_b32 v41, 0
    v_mov_b32 v26, 0
    v_mov_b32 v42, 0
    v_mov_b32 v27, 0
    v_mov_b32 v43, 0
    v_mov_b32 v28, 0
    v_mov_b32 v44, 0
    v_mov_b32 v29, 0
    v_mov_b32 v45, 0
    v_mov_b32 v30, 0
    v_mov_b32 v46, 0
    v_mov_b32 v31, 0
    v_mov_b32 v47, 0
    s_waitcnt vmcnt(0)
    s_barrier
    s_cmp_eq_u32 s44, 7
    s_cbranch_scc0 Lpf_26
    s_lshl_b32 s47, s3, 7
    s_add_u32 s47, s47, 73728
    v_mov_b32 v3, s47
    v_mov_b32 v4, 1
    s_mov_b64 s[56:57], exec
    s_mov_b64 exec, 1
    buffer_atomic_add v4, v3, s[36:39], 0 offen
    s_mov_b64 exec, s[56:57]
Lpf_26:
    s_cmp_eq_u32 s44, 0
    s_cbranch_scc0 Lw_27
    s_lshl_b32 s47, s3, 7
    s_add_u32 s47, s47, 73728
    s_and_b32 s48, s3, 7
    s_lshl_b32 s48, s48, 10
    s_add_u32 s48, s48, 65536
    v_lshlrev_b32 v3, 7, v1
    v_add_u32 v3, s48, v3
    v_mov_b32 v5, s47
    v_cmp_gt_u32 s[56:57], 8, v1
    s_nop 1
    v_cndmask_b32 v3, v5, v3, s[56:57]
    v_mov_b32 v4, 8
    v_mov_b32 v5, 16
    v_cndmask_b32 v4, v4, v5, s[56:57]
    s_mov_b64 s[54:55], exec
    s_mov_b64 exec, 0x1ff
    buffer_load_dword v120, v3, s[36:39], 0 offen sc1
Lp_28:
    s_waitcnt vmcnt(0)
    v_cmp_ne_u32 vcc, v120, v4
    s_nop 0
    s_and_b32 s48, vcc_lo, 0xff
    s_cbranch_scc0 Lpd_29
    s_sleep 4
    buffer_load_dword v120, v3, s[36:39], 0 offen sc1
    s_branch Lp_28
Lpd_29:
    s_and_b32 s53, vcc_lo, 0x100
    s_mov_b64 exec, s[54:55]
    v_mov_b32 v5, s53
    v_mov_b32 v6, 53248
    ds_write_b32 v6, v5
    s_waitcnt lgkmcnt(0)
Lw_27:
    s_barrier
    v_mov_b32 v6, 53248
    ds_read_b32 v5, v6
    buffer_load_dwordx4 v[96:99], v11, s[36:39], 0 offen offset:0 sc1
    buffer_load_dwordx4 v[100:103], v11, s[36:39], 0 offen offset:1024 sc1
    buffer_load_dwordx4 v[104:107], v11, s[36:39], 0 offen offset:2048 sc1
    buffer_load_dwordx4 v[108:111], v11, s[36:39], 0 offen offset:3072 sc1
    buffer_load_dwordx4 v[116:119], v12, s[36:39], 0 offen sc1
    s_waitcnt lgkmcnt(0)
    v_readfirstlane_b32 s53, v5
    s_nop 0
    s_cmp_eq_u32 s53, 0
    s_cbranch_scc0 Lslow_30
    buffer_load_dwordx4 v[128:131], v13, s[36:39], 0 offen sc1
    s_mov_b32 s51, 65536
    buffer_load_dwordx4 v[132:135], v13, s[36:39], s51 offen sc1
    s_mov_b32 s51, 131072
    buffer_load_dwordx4 v[136:139], v13, s[36:39], s51 offen sc1
    s_mov_b32 s51, 196608
    buffer_load_dwordx4 v[140:143], v13, s[36:39], s51 offen sc1
    s_waitcnt vmcnt(8)
    v_cvt_pk_bf16_f32 v120, v96, v97
    v_cvt_pk_bf16_f32 v121, v98, v99
    ds_write_b64 v14, v[120:121] offset:0
    s_waitcnt vmcnt(7)
    v_cvt_pk_bf16_f32 v122, v100, v101
    v_cvt_pk_bf16_f32 v123, v102, v103
    ds_write_b64 v14, v[122:123] offset:1024
    s_waitcnt vmcnt(6)
    v_cvt_pk_bf16_f32 v124, v104, v105
    v_cvt_pk_bf16_f32 v125, v106, v107
    ds_write_b64 v14, v[124:125] offset:2048
    s_waitcnt vmcnt(5)
    v_cvt_pk_bf16_f32 v126, v108, v109
    v_cvt_pk_bf16_f32 v127, v110, v111
    ds_write_b64 v14, v[126:127] offset:3072
    s_waitcnt vmcnt(4)
    s_cmp_lt_u32 s44, 2
    s_cbranch_scc0 Lzz_32
    v_cvt_pk_bf16_f32 v94, v116, v117
    v_cvt_pk_bf16_f32 v95, v118, v119
    ds_write_b64 v15, v[94:95]
    ds_write_b64 v15, v[94:95] offset:64
Lzz_32:
    s_waitcnt lgkmcnt(0)
    s_barrier
    s_branch Ljoin_31
Lslow_30:
    s_waitcnt vmcnt(4)
    v_cvt_pk_bf16_f32 v120, v96, v97
    v_cvt_pk_bf16_f32 v121, v98, v99
    ds_write_b64 v14, v[120:121] offset:0
    s_waitcnt vmcnt(3)
    v_cvt_pk_bf16_f32 v122, v100, v101
    v_cvt_pk_bf16_f32 v123, v102, v103
    ds_write_b64 v14, v[122:123] offset:1024
    s_waitcnt vmcnt(2)
    v_cvt_pk_bf16_f32 v124, v104, v105
    v_cvt_pk_bf16_f32 v125, v106, v107
    ds_write_b64 v14, v[124:125] offset:2048
    s_waitcnt vmcnt(1)
    v_cvt_pk_bf16_f32 v126, v108, v109
    v_cvt_pk_bf16_f32 v127, v110, v111
    ds_write_b64 v14, v[126:127] offset:3072
    s_waitcnt vmcnt(0)
    s_cmp_lt_u32 s44, 2
    s_cbranch_scc0 Lzz_33
    v_cvt_pk_bf16_f32 v94, v116, v117
    v_cvt_pk_bf16_f32 v95, v118, v119
    ds_write_b64 v15, v[94:95]
    ds_write_b64 v15, v[94:95] offset:64
Lzz_33:
    s_cmp_eq_u32 s44, 0
    s_cbranch_scc0 Lw2_34
    s_mov_b64 exec, 0x100
Lp_35:
    buffer_load_dword v93, v3, s[36:39], 0 offen sc1
    s_waitcnt vmcnt(0)
    v_cmp_ne_u32 vcc, v93, v4
    s_nop 4
    s_cbranch_vccnz Lp_35
    s_mov_b64 exec, s[54:55]
Lw2_34:
    s_waitcnt lgkmcnt(0)
    s_barrier
    buffer_load_dwordx4 v[128:131], v13, s[36:39], 0 offen sc1
    s_mov_b32 s51, 65536
    buffer_load_dwordx4 v[132:135], v13, s[36:39], s51 offen sc1
    s_mov_b32 s51, 131072
    buffer_load_dwordx4 v[136:139], v13, s[36:39], s51 offen sc1
    s_mov_b32 s51, 196608
    buffer_load_dwordx4 v[140:143], v13, s[36:39], s51 offen sc1
Ljoin_31:
    ds_read_b128 v[64:67], v8 offset:0
    s_waitcnt lgkmcnt(0)
    s_waitcnt vmcnt(3)
    v_mfma_f32_32x32x16_bf16 v[48:63], v[64:67], v[128:131], 0
    s_mov_b32 s51, 262144
    buffer_load_dwordx4 v[144:147], v13, s[36:39], s51 offen sc1
    ds_read_b128 v[112:115], v8 offset:1024
    ds_read_b64_tr_b16 v[68:69], v9 offset:0
    ds_read_b64_tr_b16 v[70:71], v9 offset:1024
    ds_read_b64_tr_b16 v[72:73], v10 offset:0
    ds_read_b64_tr_b16 v[74:75], v10 offset:1024
    s_waitcnt lgkmcnt(4)
    s_waitcnt vmcnt(3)
    v_mfma_f32_32x32x16_bf16 v[96:111], v[112:115], v[132:135], 0
    s_mov_b32 s51, 327680
    buffer_load_dwordx4 v[148:151], v13, s[36:39], s51 offen sc1
    v_add_f32 v92, 0x358637bd, v56
    v_rcp_f32 v92, v92
    s_nop 0
    v_mul_f32 v48, v48, v92
    v_mul_f32 v49, v49, v92
    v_mul_f32 v50, v50, v92
    v_mul_f32 v51, v51, v92
    v_mul_f32 v52, v52, v92
    v_mul_f32 v53, v53, v92
    v_mul_f32 v54, v54, v92
    v_mul_f32 v55, v55, v92
    v_cvt_pk_bf16_f32 v84, v48, v49
    v_cvt_pk_bf16_f32 v85, v50, v51
    v_cvt_pk_bf16_f32 v86, v52, v53
    v_cvt_pk_bf16_f32 v87, v54, v55
    s_waitcnt lgkmcnt(0)
    ds_read_b128 v[64:67], v8 offset:2048
    v_mfma_f32_32x32x16_bf16 v[16:31], v[68:71], v[84:87], v[16:31]
    v_mfma_f32_32x32x16_bf16 v[32:47], v[72:75], v[84:87], v[32:47]
    ds_read_b64_tr_b16 v[76:77], v9 offset:2048
    ds_read_b64_tr_b16 v[78:79], v9 offset:3072
    ds_read_b64_tr_b16 v[80:81], v10 offset:2048
    ds_read_b64_tr_b16 v[82:83], v10 offset:3072
    s_waitcnt lgkmcnt(4)
    s_waitcnt vmcnt(3)
    v_mfma_f32_32x32x16_bf16 v[48:63], v[64:67], v[136:139], 0
    s_mov_b32 s51, 393216
    buffer_load_dwordx4 v[152:155], v13, s[36:39], s51 offen sc1
    v_add_f32 v92, 0x358637bd, v104
    v_rcp_f32 v92, v92
    s_nop 0
    v_mul_f32 v96, v96, v92
    v_mul_f32 v97, v97, v92
    v_mul_f32 v98, v98, v92
    v_mul_f32 v99, v99, v92
    v_mul_f32 v100, v100, v92
    v_mul_f32 v101, v101, v92
    v_mul_f32 v102, v102, v92
    v_mul_f32 v103, v103, v92
    v_cvt_pk_bf16_f32 v88, v96, v97
    v_cvt_pk_bf16_f32 v89, v98, v99
    v_cvt_pk_bf16_f32 v90, v100, v101
    v_cvt_pk_bf16_f32 v91, v102, v103
    s_waitcnt lgkmcnt(0)
    ds_read_b128 v[112:115], v8 offset:3072
    v_mfma_f32_32x32x16_bf16 v[16:31], v[76:79], v[88:91], v[16:31]
    v_mfma_f32_32x32x16_bf16 v[32:47], v[80:83], v[88:91], v[32:47]
    ds_read_b64_tr_b16 v[68:69], v9 offset:4096
    ds_read_b64_tr_b16 v[70:71], v9 offset:5120
    ds_read_b64_tr_b16 v[72:73], v10 offset:4096
    ds_read_b64_tr_b16 v[74:75], v10 offset:5120
    s_waitcnt lgkmcnt(4)
    s_waitcnt vmcnt(3)
    v_mfma_f32_32x32x16_bf16 v[96:111], v[112:115], v[140:143], 0
    s_mov_b32 s51, 458752
    buffer_load_dwordx4 v[156:159], v13, s[36:39], s51 offen sc1
    v_add_f32 v92, 0x358637bd, v56
    v_rcp_f32 v92, v92
    s_nop 0
    v_mul_f32 v48, v48, v92
    v_mul_f32 v49, v49, v92
    v_mul_f32 v50, v50, v92
    v_mul_f32 v51, v51, v92
    v_mul_f32 v52, v52, v92
    v_mul_f32 v53, v53, v92
    v_mul_f32 v54, v54, v92
    v_mul_f32 v55, v55, v92
    v_cvt_pk_bf16_f32 v84, v48, v49
    v_cvt_pk_bf16_f32 v85, v50, v51
    v_cvt_pk_bf16_f32 v86, v52, v53
    v_cvt_pk_bf16_f32 v87, v54, v55
    s_waitcnt lgkmcnt(0)
    ds_read_b128 v[64:67], v8 offset:4096
    v_mfma_f32_32x32x16_bf16 v[16:31], v[68:71], v[84:87], v[16:31]
    v_mfma_f32_32x32x16_bf16 v[32:47], v[72:75], v[84:87], v[32:47]
    ds_read_b64_tr_b16 v[76:77], v9 offset:6144
    ds_read_b64_tr_b16 v[78:79], v9 offset:7168
    ds_read_b64_tr_b16 v[80:81], v10 offset:6144
    ds_read_b64_tr_b16 v[82:83], v10 offset:7168
    s_waitcnt lgkmcnt(4)
    s_waitcnt vmcnt(3)
    v_mfma_f32_32x32x16_bf16 v[48:63], v[64:67], v[144:147], 0
    s_mov_b32 s51, 524288
    buffer_load_dwordx4 v[160:163], v13, s[36:39], s51 offen sc1
    v_add_f32 v92, 0x358637bd, v104
    v_rcp_f32 v92, v92
    s_nop 0
    v_mul_f32 v96, v96, v92
    v_mul_f32 v97, v97, v92
    v_mul_f32 v98, v98, v92
    v_mul_f32 v99, v99, v92
    v_mul_f32 v100, v100, v92
    v_mul_f32 v101, v101, v92
    v_mul_f32 v102, v102, v92
    v_mul_f32 v103, v103, v92
    v_cvt_pk_bf16_f32 v88, v96, v97
    v_cvt_pk_bf16_f32 v89, v98, v99
    v_cvt_pk_bf16_f32 v90, v100, v101
    v_cvt_pk_bf16_f32 v91, v102, v103
    s_waitcnt lgkmcnt(0)
    ds_read_b128 v[112:115], v8 offset:5120
    v_mfma_f32_32x32x16_bf16 v[16:31], v[76:79], v[88:91], v[16:31]
    v_mfma_f32_32x32x16_bf16 v[32:47], v[80:83], v[88:91], v[32:47]
    ds_read_b64_tr_b16 v[68:69], v9 offset:8192
    ds_read_b64_tr_b16 v[70:71], v9 offset:9216
    ds_read_b64_tr_b16 v[72:73], v10 offset:8192
    ds_read_b64_tr_b16 v[74:75], v10 offset:9216
    s_waitcnt lgkmcnt(4)
    s_waitcnt vmcnt(3)
    v_mfma_f32_32x32x16_bf16 v[96:111], v[112:115], v[148:151], 0
    s_mov_b32 s51, 589824
    buffer_load_dwordx4 v[164:167], v13, s[36:39], s51 offen sc1
    v_add_f32 v92, 0x358637bd, v56
    v_rcp_f32 v92, v92
    s_nop 0
    v_mul_f32 v48, v48, v92
    v_mul_f32 v49, v49, v92
    v_mul_f32 v50, v50, v92
    v_mul_f32 v51, v51, v92
    v_mul_f32 v52, v52, v92
    v_mul_f32 v53, v53, v92
    v_mul_f32 v54, v54, v92
    v_mul_f32 v55, v55, v92
    v_cvt_pk_bf16_f32 v84, v48, v49
    v_cvt_pk_bf16_f32 v85, v50, v51
    v_cvt_pk_bf16_f32 v86, v52, v53
    v_cvt_pk_bf16_f32 v87, v54, v55
    s_waitcnt lgkmcnt(0)
    ds_read_b128 v[64:67], v8 offset:6144
    v_mfma_f32_32x32x16_bf16 v[16:31], v[68:71], v[84:87], v[16:31]
    v_mfma_f32_32x32x16_bf16 v[32:47], v[72:75], v[84:87], v[32:47]
    ds_read_b64_tr_b16 v[76:77], v9 offset:10240
    ds_read_b64_tr_b16 v[78:79], v9 offset:11264
    ds_read_b64_tr_b16 v[80:81], v10 offset:10240
    ds_read_b64_tr_b16 v[82:83], v10 offset:11264
    s_waitcnt lgkmcnt(4)
    s_waitcnt vmcnt(3)
    v_mfma_f32_32x32x16_bf16 v[48:63], v[64:67], v[152:155], 0
    s_mov_b32 s51, 655360
    buffer_load_dwordx4 v[168:171], v13, s[36:39], s51 offen sc1
    v_add_f32 v92, 0x358637bd, v104
    v_rcp_f32 v92, v92
    s_nop 0
    v_mul_f32 v96, v96, v92
    v_mul_f32 v97, v97, v92
    v_mul_f32 v98, v98, v92
    v_mul_f32 v99, v99, v92
    v_mul_f32 v100, v100, v92
    v_mul_f32 v101, v101, v92
    v_mul_f32 v102, v102, v92
    v_mul_f32 v103, v103, v92
    v_cvt_pk_bf16_f32 v88, v96, v97
    v_cvt_pk_bf16_f32 v89, v98, v99
    v_cvt_pk_bf16_f32 v90, v100, v101
    v_cvt_pk_bf16_f32 v91, v102, v103
    s_waitcnt lgkmcnt(0)
    ds_read_b128 v[112:115], v8 offset:7168
    v_mfma_f32_32x32x16_bf16 v[16:31], v[76:79], v[88:91], v[16:31]
    v_mfma_f32_32x32x16_bf16 v[32:47], v[80:83], v[88:91], v[32:47]
    ds_read_b64_tr_b16 v[68:69], v9 offset:12288
    ds_read_b64_tr_b16 v[70:71], v9 offset:13312
    ds_read_b64_tr_b16 v[72:73], v10 offset:12288
    ds_read_b64_tr_b16 v[74:75], v10 offset:13312
    s_waitcnt lgkmcnt(4)
    s_waitcnt vmcnt(3)
    v_mfma_f32_32x32x16_bf16 v[96:111], v[112:115], v[156:159], 0
    s_mov_b32 s51, 720896
    buffer_load_dwordx4 v[172:175], v13, s[36:39], s51 offen sc1
    v_add_f32 v92, 0x358637bd, v56
    v_rcp_f32 v92, v92
    s_nop 0
    v_mul_f32 v48, v48, v92
    v_mul_f32 v49, v49, v92
    v_mul_f32 v50, v50, v92
    v_mul_f32 v51, v51, v92
    v_mul_f32 v52, v52, v92
    v_mul_f32 v53, v53, v92
    v_mul_f32 v54, v54, v92
    v_mul_f32 v55, v55, v92
    v_cvt_pk_bf16_f32 v84, v48, v49
    v_cvt_pk_bf16_f32 v85, v50, v51
    v_cvt_pk_bf16_f32 v86, v52, v53
    v_cvt_pk_bf16_f32 v87, v54, v55
    s_waitcnt lgkmcnt(0)
    ds_read_b128 v[64:67], v8 offset:8192
    v_mfma_f32_32x32x16_bf16 v[16:31], v[68:71], v[84:87], v[16:31]
    v_mfma_f32_32x32x16_bf16 v[32:47], v[72:75], v[84:87], v[32:47]
    ds_read_b64_tr_b16 v[76:77], v9 offset:14336
    ds_read_b64_tr_b16 v[78:79], v9 offset:15360
    ds_read_b64_tr_b16 v[80:81], v10 offset:14336
    ds_read_b64_tr_b16 v[82:83], v10 offset:15360
    s_waitcnt lgkmcnt(4)
    s_waitcnt vmcnt(3)
    v_mfma_f32_32x32x16_bf16 v[48:63], v[64:67], v[160:163], 0
    s_mov_b32 s51, 786432
    buffer_load_dwordx4 v[176:179], v13, s[36:39], s51 offen sc1
    v_add_f32 v92, 0x358637bd, v104
    v_rcp_f32 v92, v92
    s_nop 0
    v_mul_f32 v96, v96, v92
    v_mul_f32 v97, v97, v92
    v_mul_f32 v98, v98, v92
    v_mul_f32 v99, v99, v92
    v_mul_f32 v100, v100, v92
    v_mul_f32 v101, v101, v92
    v_mul_f32 v102, v102, v92
    v_mul_f32 v103, v103, v92
    v_cvt_pk_bf16_f32 v88, v96, v97
    v_cvt_pk_bf16_f32 v89, v98, v99
    v_cvt_pk_bf16_f32 v90, v100, v101
    v_cvt_pk_bf16_f32 v91, v102, v103
    s_waitcnt lgkmcnt(0)
    ds_read_b128 v[112:115], v8 offset:9216
    v_mfma_f32_32x32x16_bf16 v[16:31], v[76:79], v[88:91], v[16:31]
    v_mfma_f32_32x32x16_bf16 v[32:47], v[80:83], v[88:91], v[32:47]
    ds_read_b64_tr_b16 v[68:69], v9 offset:16384
    ds_read_b64_tr_b16 v[70:71], v9 offset:17408
    ds_read_b64_tr_b16 v[72:73], v10 offset:16384
    ds_read_b64_tr_b16 v[74:75], v10 offset:17408
    s_waitcnt lgkmcnt(4)
    s_waitcnt vmcnt(3)
    v_mfma_f32_32x32x16_bf16 v[96:111], v[112:115], v[164:167], 0
    s_mov_b32 s51, 851968
    buffer_load_dwordx4 v[180:183], v13, s[36:39], s51 offen sc1
    v_add_f32 v92, 0x358637bd, v56
    v_rcp_f32 v92, v92
    s_nop 0
    v_mul_f32 v48, v48, v92
    v_mul_f32 v49, v49, v92
    v_mul_f32 v50, v50, v92
    v_mul_f32 v51, v51, v92
    v_mul_f32 v52, v52, v92
    v_mul_f32 v53, v53, v92
    v_mul_f32 v54, v54, v92
    v_mul_f32 v55, v55, v92
    v_cvt_pk_bf16_f32 v84, v48, v49
    v_cvt_pk_bf16_f32 v85, v50, v51
    v_cvt_pk_bf16_f32 v86, v52, v53
    v_cvt_pk_bf16_f32 v87, v54, v55
    s_waitcnt lgkmcnt(0)
    ds_read_b128 v[64:67], v8 offset:10240
    v_mfma_f32_32x32x16_bf16 v[16:31], v[68:71], v[84:87], v[16:31]
    v_mfma_f32_32x32x16_bf16 v[32:47], v[72:75], v[84:87], v[32:47]
    ds_read_b64_tr_b16 v[76:77], v9 offset:18432
    ds_read_b64_tr_b16 v[78:79], v9 offset:19456
    ds_read_b64_tr_b16 v[80:81], v10 offset:18432
    ds_read_b64_tr_b16 v[82:83], v10 offset:19456
    s_waitcnt lgkmcnt(4)
    s_waitcnt vmcnt(3)
    v_mfma_f32_32x32x16_bf16 v[48:63], v[64:67], v[168:171], 0
    s_mov_b32 s51, 917504
    buffer_load_dwordx4 v[184:187], v13, s[36:39], s51 offen sc1
    v_add_f32 v92, 0x358637bd, v104
    v_rcp_f32 v92, v92
    s_nop 0
    v_mul_f32 v96, v96, v92
    v_mul_f32 v97, v97, v92
    v_mul_f32 v98, v98, v92
    v_mul_f32 v99, v99, v92
    v_mul_f32 v100, v100, v92
    v_mul_f32 v101, v101, v92
    v_mul_f32 v102, v102, v92
    v_mul_f32 v103, v103, v92
    v_cvt_pk_bf16_f32 v88, v96, v97
    v_cvt_pk_bf16_f32 v89, v98, v99
    v_cvt_pk_bf16_f32 v90, v100, v101
    v_cvt_pk_bf16_f32 v91, v102, v103
    s_waitcnt lgkmcnt(0)
    ds_read_b128 v[112:115], v8 offset:11264
    v_mfma_f32_32x32x16_bf16 v[16:31], v[76:79], v[88:91], v[16:31]
    v_mfma_f32_32x32x16_bf16 v[32:47], v[80:83], v[88:91], v[32:47]
    ds_read_b64_tr_b16 v[68:69], v9 offset:20480
    ds_read_b64_tr_b16 v[70:71], v9 offset:21504
    ds_read_b64_tr_b16 v[72:73], v10 offset:20480
    ds_read_b64_tr_b16 v[74:75], v10 offset:21504
    s_waitcnt lgkmcnt(4)
    s_waitcnt vmcnt(3)
    v_mfma_f32_32x32x16_bf16 v[96:111], v[112:115], v[172:175], 0
    s_mov_b32 s51, 983040
    buffer_load_dwordx4 v[188:191], v13, s[36:39], s51 offen sc1
    v_add_f32 v92, 0x358637bd, v56
    v_rcp_f32 v92, v92
    s_nop 0
    v_mul_f32 v48, v48, v92
    v_mul_f32 v49, v49, v92
    v_mul_f32 v50, v50, v92
    v_mul_f32 v51, v51, v92
    v_mul_f32 v52, v52, v92
    v_mul_f32 v53, v53, v92
    v_mul_f32 v54, v54, v92
    v_mul_f32 v55, v55, v92
    v_cvt_pk_bf16_f32 v84, v48, v49
    v_cvt_pk_bf16_f32 v85, v50, v51
    v_cvt_pk_bf16_f32 v86, v52, v53
    v_cvt_pk_bf16_f32 v87, v54, v55
    s_waitcnt lgkmcnt(0)
    ds_read_b128 v[64:67], v8 offset:12288
    v_mfma_f32_32x32x16_bf16 v[16:31], v[68:71], v[84:87], v[16:31]
    v_mfma_f32_32x32x16_bf16 v[32:47], v[72:75], v[84:87], v[32:47]
    ds_read_b64_tr_b16 v[76:77], v9 offset:22528
    ds_read_b64_tr_b16 v[78:79], v9 offset:23552
    ds_read_b64_tr_b16 v[80:81], v10 offset:22528
    ds_read_b64_tr_b16 v[82:83], v10 offset:23552
    s_waitcnt lgkmcnt(4)
    s_waitcnt vmcnt(3)
    v_mfma_f32_32x32x16_bf16 v[48:63], v[64:67], v[176:179], 0
    v_add_f32 v92, 0x358637bd, v104
    v_rcp_f32 v92, v92
    s_nop 0
    v_mul_f32 v96, v96, v92
    v_mul_f32 v97, v97, v92
    v_mul_f32 v98, v98, v92
    v_mul_f32 v99, v99, v92
    v_mul_f32 v100, v100, v92
    v_mul_f32 v101, v101, v92
    v_mul_f32 v102, v102, v92
    v_mul_f32 v103, v103, v92
    v_cvt_pk_bf16_f32 v88, v96, v97
    v_cvt_pk_bf16_f32 v89, v98, v99
    v_cvt_pk_bf16_f32 v90, v100, v101
    v_cvt_pk_bf16_f32 v91, v102, v103
    s_waitcnt lgkmcnt(0)
    ds_read_b128 v[112:115], v8 offset:13312
    v_mfma_f32_32x32x16_bf16 v[16:31], v[76:79], v[88:91], v[16:31]
    v_mfma_f32_32x32x16_bf16 v[32:47], v[80:83], v[88:91], v[32:47]
    ds_read_b64_tr_b16 v[68:69], v9 offset:24576
    ds_read_b64_tr_b16 v[70:71], v9 offset:25600
    ds_read_b64_tr_b16 v[72:73], v10 offset:24576
    ds_read_b64_tr_b16 v[74:75], v10 offset:25600
    s_waitcnt lgkmcnt(4)
    s_waitcnt vmcnt(2)
    v_mfma_f32_32x32x16_bf16 v[96:111], v[112:115], v[180:183], 0
    v_add_f32 v92, 0x358637bd, v56
    v_rcp_f32 v92, v92
    s_nop 0
    v_mul_f32 v48, v48, v92
    v_mul_f32 v49, v49, v92
    v_mul_f32 v50, v50, v92
    v_mul_f32 v51, v51, v92
    v_mul_f32 v52, v52, v92
    v_mul_f32 v53, v53, v92
    v_mul_f32 v54, v54, v92
    v_mul_f32 v55, v55, v92
    v_cvt_pk_bf16_f32 v84, v48, v49
    v_cvt_pk_bf16_f32 v85, v50, v51
    v_cvt_pk_bf16_f32 v86, v52, v53
    v_cvt_pk_bf16_f32 v87, v54, v55
    s_waitcnt lgkmcnt(0)
    ds_read_b128 v[64:67], v8 offset:14336
    v_mfma_f32_32x32x16_bf16 v[16:31], v[68:71], v[84:87], v[16:31]
    v_mfma_f32_32x32x16_bf16 v[32:47], v[72:75], v[84:87], v[32:47]
    ds_read_b64_tr_b16 v[76:77], v9 offset:26624
    ds_read_b64_tr_b16 v[78:79], v9 offset:27648
    ds_read_b64_tr_b16 v[80:81], v10 offset:26624
    ds_read_b64_tr_b16 v[82:83], v10 offset:27648
    s_waitcnt lgkmcnt(4)
    s_waitcnt vmcnt(1)
    v_mfma_f32_32x32x16_bf16 v[48:63], v[64:67], v[184:187], 0
    v_add_f32 v92, 0x358637bd, v104
    v_rcp_f32 v92, v92
    s_nop 0
    v_mul_f32 v96, v96, v92
    v_mul_f32 v97, v97, v92
    v_mul_f32 v98, v98, v92
    v_mul_f32 v99, v99, v92
    v_mul_f32 v100, v100, v92
    v_mul_f32 v101, v101, v92
    v_mul_f32 v102, v102, v92
    v_mul_f32 v103, v103, v92
    v_cvt_pk_bf16_f32 v88, v96, v97
    v_cvt_pk_bf16_f32 v89, v98, v99
    v_cvt_pk_bf16_f32 v90, v100, v101
    v_cvt_pk_bf16_f32 v91, v102, v103
    s_waitcnt lgkmcnt(0)
    ds_read_b128 v[112:115], v8 offset:15360
    v_mfma_f32_32x32x16_bf16 v[16:31], v[76:79], v[88:91], v[16:31]
    v_mfma_f32_32x32x16_bf16 v[32:47], v[80:83], v[88:91], v[32:47]
    ds_read_b64_tr_b16 v[68:69], v9 offset:28672
    ds_read_b64_tr_b16 v[70:71], v9 offset:29696
    ds_read_b64_tr_b16 v[72:73], v10 offset:28672
    ds_read_b64_tr_b16 v[74:75], v10 offset:29696
    s_waitcnt lgkmcnt(4)
    s_waitcnt vmcnt(0)
    v_mfma_f32_32x32x16_bf16 v[96:111], v[112:115], v[188:191], 0
    v_add_f32 v92, 0x358637bd, v56
    v_rcp_f32 v92, v92
    s_nop 0
    v_mul_f32 v48, v48, v92
    v_mul_f32 v49, v49, v92
    v_mul_f32 v50, v50, v92
    v_mul_f32 v51, v51, v92
    v_mul_f32 v52, v52, v92
    v_mul_f32 v53, v53, v92
    v_mul_f32 v54, v54, v92
    v_mul_f32 v55, v55, v92
    v_cvt_pk_bf16_f32 v84, v48, v49
    v_cvt_pk_bf16_f32 v85, v50, v51
    v_cvt_pk_bf16_f32 v86, v52, v53
    v_cvt_pk_bf16_f32 v87, v54, v55
    s_waitcnt lgkmcnt(0)
    s_nop 0
    v_mfma_f32_32x32x16_bf16 v[16:31], v[68:71], v[84:87], v[16:31]
    v_mfma_f32_32x32x16_bf16 v[32:47], v[72:75], v[84:87], v[32:47]
    ds_read_b64_tr_b16 v[76:77], v9 offset:30720
    ds_read_b64_tr_b16 v[78:79], v9 offset:31744
    ds_read_b64_tr_b16 v[80:81], v10 offset:30720
    ds_read_b64_tr_b16 v[82:83], v10 offset:31744
    v_add_f32 v92, 0x358637bd, v104
    v_rcp_f32 v92, v92
    s_nop 0
    v_mul_f32 v96, v96, v92
    v_mul_f32 v97, v97, v92
    v_mul_f32 v98, v98, v92
    v_mul_f32 v99, v99, v92
    v_mul_f32 v100, v100, v92
    v_mul_f32 v101, v101, v92
    v_mul_f32 v102, v102, v92
    v_mul_f32 v103, v103, v92
    v_cvt_pk_bf16_f32 v88, v96, v97
    v_cvt_pk_bf16_f32 v89, v98, v99
    v_cvt_pk_bf16_f32 v90, v100, v101
    v_cvt_pk_bf16_f32 v91, v102, v103
    s_waitcnt lgkmcnt(0)
    s_nop 0
    v_mfma_f32_32x32x16_bf16 v[16:31], v[76:79], v[88:91], v[16:31]
    v_mfma_f32_32x32x16_bf16 v[32:47], v[80:83], v[88:91], v[32:47]
    s_cmp_eq_u32 s46, 0
    s_cbranch_scc0 Lx_37
    s_nop 9
    ds_write_b128 v192, v[32:35] offset:0
    ds_write_b128 v192, v[36:39] offset:1024
    ds_write_b128 v192, v[40:43] offset:2048
    ds_write_b128 v192, v[44:47] offset:3072
    s_branch Lx_38
Lx_37:
    s_nop 8
    ds_write_b128 v192, v[16:19] offset:0
    ds_write_b128 v192, v[20:23] offset:1024
    ds_write_b128 v192, v[24:27] offset:2048
    ds_write_b128 v192, v[28:31] offset:3072
Lx_38:
    s_waitcnt lgkmcnt(0)
    s_barrier
    ds_read_b128 v[48:51], v193 offset:0
    ds_read_b128 v[52:55], v193 offset:1024
    ds_read_b128 v[56:59], v193 offset:2048
    ds_read_b128 v[60:63], v193 offset:3072
    s_cmp_eq_u32 s46, 0
    s_cbranch_scc0 Lx_39
    s_waitcnt lgkmcnt(0)
    v_add_f32 v48, v48, v16
    v_add_f32 v49, v49, v17
    v_add_f32 v50, v50, v18
    v_add_f32 v51, v51, v19
    v_add_f32 v52, v52, v20
    v_add_f32 v53, v53, v21
    v_add_f32 v54, v54, v22
    v_add_f32 v55, v55, v23
    v_add_f32 v56, v56, v24
    v_add_f32 v57, v57, v25
    v_add_f32 v58, v58, v26
    v_add_f32 v59, v59, v27
    v_add_f32 v60, v60, v28
    v_add_f32 v61, v61, v29
    v_add_f32 v62, v62, v30
    v_add_f32 v63, v63, v31
    s_branch Lx_40
Lx_39:
    s_waitcnt lgkmcnt(0)
    v_add_f32 v48, v48, v32
    v_add_f32 v49, v49, v33
    v_add_f32 v50, v50, v34
    v_add_f32 v51, v51, v35
    v_add_f32 v52, v52, v36
    v_add_f32 v53, v53, v37
    v_add_f32 v54, v54, v38
    v_add_f32 v55, v55, v39
    v_add_f32 v56, v56, v40
    v_add_f32 v57, v57, v41
    v_add_f32 v58, v58, v42
    v_add_f32 v59, v59, v43
    v_add_f32 v60, v60, v44
    v_add_f32 v61, v61, v45
    v_add_f32 v62, v62, v46
    v_add_f32 v63, v63, v47
Lx_40:
    v_cvt_pk_bf16_f32 v64, v48, v49
    v_cvt_pk_bf16_f32 v65, v50, v51
    ds_write_b64 v194, v[64:65] offset:0
    v_cvt_pk_bf16_f32 v66, v52, v53
    v_cvt_pk_bf16_f32 v67, v54, v55
    ds_write_b64 v194, v[66:67] offset:16
    v_cvt_pk_bf16_f32 v68, v56, v57
    v_cvt_pk_bf16_f32 v69, v58, v59
    ds_write_b64 v194, v[68:69] offset:32
    v_cvt_pk_bf16_f32 v70, v60, v61
    v_cvt_pk_bf16_f32 v71, v62, v63
    ds_write_b64 v194, v[70:71] offset:48
    s_waitcnt lgkmcnt(0)
    s_barrier
    ds_read_b128 v[76:79], v195
    ds_read_b128 v[80:83], v195 offset:1152
    s_mov_b32 s51, 16384
    s_waitcnt lgkmcnt(1)
    buffer_store_dwordx4 v[76:79], v196, s[64:67], 0 offen
    s_waitcnt lgkmcnt(0)
    buffer_store_dwordx4 v[80:83], v196, s[64:67], s51 offen
    s_waitcnt vmcnt(0)
LF_end:
    s_endpgm

.section .rodata,"a"
.p2align 6
.amdhsa_kernel concat_heads__ssm_conv_s4__linear_attn_block__prompt_kernel
  .amdhsa_next_free_vgpr 256
  .amdhsa_next_free_sgpr 102
  .amdhsa_accum_offset 256
  .amdhsa_group_segment_fixed_size 0
  .amdhsa_kernarg_size 120
  .amdhsa_user_sgpr_count 2
  .amdhsa_user_sgpr_kernarg_segment_ptr 1
  .amdhsa_system_sgpr_workgroup_id_x 1
.end_amdhsa_kernel
```
